```python
import torch

def _softmax(x, axis=-1):
    return torch.softmax(x, dim=axis)
def _gelu(x):
    return torch.nn.functional.gelu(x, approximate="tanh")
def _silu(x):
    return torch.nn.functional.silu(x)
def _sigmoid(x):
    return torch.sigmoid(x)
def _layernorm(x, axis=-1, eps=1e-5):
    m = x.mean(dim=axis, keepdim=True)
    v = x.var(dim=axis, keepdim=True, unbiased=False)
    return (x - m) / torch.sqrt(v + eps)
def _scatter_add(tgt, idx, src, axis=0):
    return tgt.clone().index_add_(axis, idx, src)
def _segment_sum(src, seg, n):
    out = torch.zeros((n,) + src.shape[1:], dtype=src.dtype)
    return out.index_add_(0, seg, src)
def _pad(x, pw):
    flat = tuple(v for pair in reversed(pw) for v in pair)
    return torch.nn.functional.pad(x, flat)

kernel_name = 'standalone__hybrid_graph_tf_nagphormer__graph'

def setup_inputs():

    _w = (lambda a: (lambda t: t.to(torch.bfloat16) if t.is_floating_point() else t)(torch.as_tensor(a)))
    N, deg, D = 12500, 32, 128
    E = N * deg
    src = (lambda lo, hi, *s: torch.randint(lo, hi, s))(0, N, E).to(torch.int64)
    dst = (lambda lo, hi, *s: torch.randint(lo, hi, s))(0, N, E).to(torch.int64)
    deg_cnt = torch.bincount(dst, minlength=N).to(float) + 1.0
    sc = 1.0 / D ** 0.5
    return {
        "x": _w((lambda *s: torch.randn(*s, dtype=torch.bfloat16) * 0.1)(N, D)),
        "src": _w(src),
        "dst": _w(dst),
        "deg_inv_sqrt": _w(1.0 / (lambda _x: torch.sqrt(torch.as_tensor(_x)))(deg_cnt)),
        "wq": _w((lambda *s: torch.randn(*s, dtype=torch.bfloat16) * 1.6)(D, D) * sc),
        "wk": _w((lambda *s: torch.randn(*s, dtype=torch.bfloat16) * 1.6)(D, D) * sc),
        "wv": _w((lambda *s: torch.randn(*s, dtype=torch.bfloat16) * 0.1)(D, D) * sc),
        "wo": _w((lambda *s: torch.randn(*s, dtype=torch.bfloat16) * 0.1)(D, D) * sc),
        "w_r": _w((lambda *s: torch.randn(*s, dtype=torch.bfloat16) * 0.1)(D)),
    }

def reference(x, src, dst, deg_inv_sqrt, wq, wk, wv, wo, w_r):
    N, D = x.shape[0], x.shape[1]
    K = 7
    h = x
    toks = [x]
    for _ in range(K):
        msg = h[src] * deg_inv_sqrt[src, None] * deg_inv_sqrt[dst, None]
        h = _segment_sum(msg, dst, N)
        toks.append(h)
    tok = torch.stack(toks, axis=1)
    t = _layernorm(tok, axis=-1)
    q   = torch.einsum('nkd,de->nke', t, wq)
    key = torch.einsum('nkd,de->nke', t, wk)
    v   = torch.einsum('nkd,de->nke', t, wv)
    scale = 1.0 / (D ** 0.5)
    attn = _softmax(torch.einsum('nkd,nld->nkl', q, key) * scale, axis=-1)
    o = torch.einsum('nkl,nld->nkd', attn, v)
    o = tok + torch.einsum('nkd,de->nke', o, wo)
    r = _layernorm(o, axis=-1)
    alpha = _softmax(torch.einsum('nkd,d->nk', r, w_r), axis=-1)
    return torch.einsum('nk,nkd->nd', alpha, o)
```

```asm
; @launch kernel=k1_kernel grid=(204,1,1) block=(512,1,1) lds=30720
; @launch kernel=k2_kernel grid=(202,1,1) block=(1024,1,1) lds=77824
; @launch kernel=k3_kernel grid=(256,1,1) block=(1024,1,1) lds=137280
; @launch kernel=k4_kernel grid=(256,1,1) block=(832,1,1) lds=163840
.amdgcn_target "amdgcn-amd-amdhsa--gfx950"
.text
.globl k1_kernel
.p2align 8
.type k1_kernel,@function
k1_kernel:
  s_cmp_ge_u32 s2, 196
  s_cbranch_scc1 K1_PF
  s_load_dwordx8 s[56:63], s[0:1], 0
  s_load_dwordx2 s[12:13], s[0:1], 88
  v_lshlrev_b32 v1, 4, v0
  s_lshl_b32 s14, s2, 13
  v_mov_b32 v20, 0
  v_mov_b32 v21, 0
  v_mov_b32 v22, 0
  v_mov_b32 v23, 0
  ds_write_b128 v1, v[20:23]
  ds_write_b128 v1, v[20:23] offset:8192
  ds_write_b128 v1, v[20:23] offset:16384
  ds_write_b128 v1, v[20:23] offset:22528
  v_and_b32 v42, 7, v0
  v_bfe_u32 v43, v0, 7, 1
  v_lshlrev_b32 v44, 4, v42
  v_lshl_or_b32 v44, v43, 8, v44
  v_lshl_or_b32 v42, v42, 1, v43
  v_bfe_u32 v43, v0, 3, 4
  v_lshrrev_b32 v46, 8, v0
  v_lshl_or_b32 v47, v42, 2, v46
  v_lshlrev_b32 v47, 8, v47
  v_lshl_or_b32 v47, v43, 4, v47
  s_lshl_b32 s15, s2, 14
  s_lshl_b32 s3, s2, 7
  s_waitcnt lgkmcnt(0)
  s_mov_b32 s16, s58
  s_and_b32 s17, s59, 0xffff
  s_mov_b32 s18, 1600000
  s_mov_b32 s19, 0x00020000
  s_mov_b32 s20, s60
  s_and_b32 s21, s61, 0xffff
  s_mov_b32 s22, 1600000
  s_mov_b32 s23, 0x00020000
  buffer_load_dwordx4 v[4:7], v1, s[16:19], s14 offen
  buffer_load_dwordx4 v[24:27], v1, s[20:23], s14 offen
  s_mov_b32 s24, s56
  s_and_b32 s25, s57, 0xffff
  s_mov_b32 s26, 3200000
  s_mov_b32 s27, 0x00020000
  s_mov_b32 s28, s62
  s_and_b32 s29, s63, 0xffff
  s_mov_b32 s30, 25000
  s_mov_b32 s31, 0x00020000
  buffer_load_dwordx4 v[32:35], v47, s[24:27], s15 offen
  buffer_load_dwordx4 v[36:39], v47, s[24:27], s15 offen offset:512
  v_lshlrev_b32 v47, 3, v42
  buffer_load_dwordx2 v[40:41], v47, s[28:31], s3 offen
  v_mul_u32_u24 v43, 200704, v43
  v_add_u32 v43, v44, v43
  v_mul_u32_u24 v42, 50176, v46
  v_add_u32 v43, v43, v42
  v_lshlrev_b32 v46, 4, v46
  s_lshr_b32 s4, s2, 1
  s_lshl_b32 s4, s4, 9
  s_and_b32 s5, s2, 1
  s_lshl_b32 s5, s5, 7
  s_add_u32 s4, s4, s5
  s_add_u32 s4, s4, 33554432
  s_add_u32 s5, s4, 100352
  s_mov_b32 s6, 0x07060302
  s_mov_b32 s7, 0x10000
  s_movk_i32 s8, 6272
  s_mov_b32 s32, s12
  s_and_b32 s33, s13, 0xffff
  s_mov_b32 s34, 268435456
  s_mov_b32 s35, 0x00020000
  v_add_u32 v44, s14, v1
  s_movk_i32 s38, 12500
  s_movk_i32 s39, 12288
  s_brev_b32 s40, 1
  v_cmp_gt_u32 vcc, 1600000, v44
  s_mov_b64 s[42:43], vcc
  v_mov_b32 v45, 1
  s_movk_i32 s54, 144
  s_movk_i32 s55, 25088
  v_lshrrev_b32 v28, 3, v0
  v_and_b32 v29, 7, v0
  v_lshlrev_b32 v29, 4, v29
  v_mad_u32_u24 v2, v28, s54, v29
  v_mad_u32_u24 v3, v28, s55, v29
  s_barrier
  s_waitcnt vmcnt(3)
  v_cmp_gt_u32 vcc, s38, v24
  v_cmp_gt_u32 s[44:45], s38, v4
  v_lshrrev_b32 v28, 6, v24
  v_bfi_b32 v28, 1, v24, v28
  v_lshrrev_b32 v29, 5, v24
  s_and_b64 vcc, vcc, s[42:43]
  s_and_b64 s[44:45], s[44:45], vcc
  v_subrev_u32 v29, 192, v29
  v_cmp_gt_u32 vcc, s39, v24
  s_nop 1
  v_cndmask_b32 v8, v29, v28, vcc
  v_lshlrev_b32 v29, 2, v8
  s_mov_b64 exec, s[44:45]
  ds_add_rtn_u32 v56, v29, v45 offset:28800
  s_mov_b64 exec, -1
  v_and_b32 v30, 1, v4
  v_lshrrev_b32 v28, 1, v4
  v_lshrrev_b32 v29, 2, v4
  v_bfi_b32 v28, 30, v29, v28
  v_lshlrev_b32 v29, 3, v4
  v_bfi_b32 v28, 32, v29, v28
  v_mad_u32_u24 v4, v30, s8, v28
  v_lshrrev_b32 v30, 1, v24
  v_bfi_b32 v31, 31, v24, v4
  v_cndmask_b32 v30, v31, v30, vcc
  v_and_b32 v30, 63, v30
  v_lshl_or_b32 v52, v30, 16, v4
  v_or_b32 v52, s40, v52
  v_mul_u32_u24 v48, 144, v8
  v_cmp_gt_u32 vcc, s38, v25
  v_cmp_gt_u32 s[46:47], s38, v5
  v_lshrrev_b32 v28, 6, v25
  v_bfi_b32 v28, 1, v25, v28
  v_lshrrev_b32 v29, 5, v25
  s_and_b64 vcc, vcc, s[42:43]
  s_and_b64 s[46:47], s[46:47], vcc
  v_subrev_u32 v29, 192, v29
  v_cmp_gt_u32 vcc, s39, v25
  s_nop 1
  v_cndmask_b32 v9, v29, v28, vcc
  v_lshlrev_b32 v29, 2, v9
  s_mov_b64 exec, s[46:47]
  ds_add_rtn_u32 v57, v29, v45 offset:28800
  s_mov_b64 exec, -1
  v_and_b32 v30, 1, v5
  v_lshrrev_b32 v28, 1, v5
  v_lshrrev_b32 v29, 2, v5
  v_bfi_b32 v28, 30, v29, v28
  v_lshlrev_b32 v29, 3, v5
  v_bfi_b32 v28, 32, v29, v28
  v_mad_u32_u24 v5, v30, s8, v28
  v_lshrrev_b32 v30, 1, v25
  v_bfi_b32 v31, 31, v25, v5
  v_cndmask_b32 v30, v31, v30, vcc
  v_and_b32 v30, 63, v30
  v_lshl_or_b32 v53, v30, 16, v5
  v_or_b32 v53, s40, v53
  v_mul_u32_u24 v49, 144, v9
  v_cmp_gt_u32 vcc, s38, v26
  v_cmp_gt_u32 s[48:49], s38, v6
  v_lshrrev_b32 v28, 6, v26
  v_bfi_b32 v28, 1, v26, v28
  v_lshrrev_b32 v29, 5, v26
  s_and_b64 vcc, vcc, s[42:43]
  s_and_b64 s[48:49], s[48:49], vcc
  v_subrev_u32 v29, 192, v29
  v_cmp_gt_u32 vcc, s39, v26
  s_nop 1
  v_cndmask_b32 v10, v29, v28, vcc
  v_lshlrev_b32 v29, 2, v10
  s_mov_b64 exec, s[48:49]
  ds_add_rtn_u32 v58, v29, v45 offset:28800
  s_mov_b64 exec, -1
  v_and_b32 v30, 1, v6
  v_lshrrev_b32 v28, 1, v6
  v_lshrrev_b32 v29, 2, v6
  v_bfi_b32 v28, 30, v29, v28
  v_lshlrev_b32 v29, 3, v6
  v_bfi_b32 v28, 32, v29, v28
  v_mad_u32_u24 v6, v30, s8, v28
  v_lshrrev_b32 v30, 1, v26
  v_bfi_b32 v31, 31, v26, v6
  v_cndmask_b32 v30, v31, v30, vcc
  v_and_b32 v30, 63, v30
  v_lshl_or_b32 v54, v30, 16, v6
  v_or_b32 v54, s40, v54
  v_mul_u32_u24 v50, 144, v10
  v_cmp_gt_u32 vcc, s38, v27
  v_cmp_gt_u32 s[50:51], s38, v7
  v_lshrrev_b32 v28, 6, v27
  v_bfi_b32 v28, 1, v27, v28
  v_lshrrev_b32 v29, 5, v27
  s_and_b64 vcc, vcc, s[42:43]
  s_and_b64 s[50:51], s[50:51], vcc
  v_subrev_u32 v29, 192, v29
  v_cmp_gt_u32 vcc, s39, v27
  s_nop 1
  v_cndmask_b32 v11, v29, v28, vcc
  v_lshlrev_b32 v29, 2, v11
  s_mov_b64 exec, s[50:51]
  ds_add_rtn_u32 v59, v29, v45 offset:28800
  s_mov_b64 exec, -1
  v_and_b32 v30, 1, v7
  v_lshrrev_b32 v28, 1, v7
  v_lshrrev_b32 v29, 2, v7
  v_bfi_b32 v28, 30, v29, v28
  v_lshlrev_b32 v29, 3, v7
  v_bfi_b32 v28, 32, v29, v28
  v_mad_u32_u24 v7, v30, s8, v28
  v_lshrrev_b32 v30, 1, v27
  v_bfi_b32 v31, 31, v27, v7
  v_cndmask_b32 v30, v31, v30, vcc
  v_and_b32 v30, 63, v30
  v_lshl_or_b32 v55, v30, 16, v7
  v_or_b32 v55, s40, v55
  v_mul_u32_u24 v51, 144, v11
  s_waitcnt vmcnt(0)
  v_lshrrev_b32 v40, v46, v40
  v_lshrrev_b32 v41, v46, v41
  v_and_b32 v28, 0xffff, v40
  v_lshlrev_b32 v29, 16, v40
  v_and_b32 v30, 0xffff, v41
  v_lshlrev_b32 v31, 16, v41
  v_dot2_f32_bf16 v24, v32, v28, 0
  v_dot2_f32_bf16 v25, v32, v29, 0
  v_dot2_f32_bf16 v26, v33, v28, 0
  v_dot2_f32_bf16 v27, v33, v29, 0
  v_add_u32 v24, s7, v24
  v_cvt_pk_bf16_f32 v25, v25, v25
  v_perm_b32 v24, v25, v24, s6
  v_and_b32 v12, -2, v24
  v_add_u32 v26, s7, v26
  v_cvt_pk_bf16_f32 v27, v27, v27
  v_perm_b32 v26, v27, v26, s6
  v_and_b32 v13, -2, v26
  v_dot2_f32_bf16 v24, v34, v28, 0
  v_dot2_f32_bf16 v25, v34, v29, 0
  v_dot2_f32_bf16 v26, v35, v28, 0
  v_dot2_f32_bf16 v27, v35, v29, 0
  v_add_u32 v24, s7, v24
  v_cvt_pk_bf16_f32 v25, v25, v25
  v_perm_b32 v24, v25, v24, s6
  v_and_b32 v16, -2, v24
  v_add_u32 v26, s7, v26
  v_cvt_pk_bf16_f32 v27, v27, v27
  v_perm_b32 v26, v27, v26, s6
  v_and_b32 v17, -2, v26
  v_dot2_f32_bf16 v24, v36, v30, 0
  v_dot2_f32_bf16 v25, v36, v31, 0
  v_dot2_f32_bf16 v26, v37, v30, 0
  v_dot2_f32_bf16 v27, v37, v31, 0
  v_add_u32 v24, s7, v24
  v_cvt_pk_bf16_f32 v25, v25, v25
  v_perm_b32 v24, v25, v24, s6
  v_and_b32 v14, -2, v24
  v_add_u32 v26, s7, v26
  v_cvt_pk_bf16_f32 v27, v27, v27
  v_perm_b32 v26, v27, v26, s6
  v_and_b32 v15, -2, v26
  v_dot2_f32_bf16 v24, v38, v30, 0
  v_dot2_f32_bf16 v25, v38, v31, 0
  v_dot2_f32_bf16 v26, v39, v30, 0
  v_dot2_f32_bf16 v27, v39, v31, 0
  v_add_u32 v24, s7, v24
  v_cvt_pk_bf16_f32 v25, v25, v25
  v_perm_b32 v24, v25, v24, s6
  v_and_b32 v18, -2, v24
  v_add_u32 v26, s7, v26
  v_cvt_pk_bf16_f32 v27, v27, v27
  v_perm_b32 v26, v27, v26, s6
  v_and_b32 v19, -2, v26
  buffer_store_dwordx4 v[12:15], v43, s[32:35], s4 offen sc1
  buffer_store_dwordx4 v[16:19], v43, s[32:35], s5 offen sc1
  s_mov_b64 s[52:53], 0
  s_waitcnt lgkmcnt(3)
  v_cmp_gt_u32 vcc, 32, v56
  v_lshl_add_u32 v29, v56, 2, v48
  s_and_b64 exec, vcc, s[44:45]
  ds_write_b32 v29, v52
  s_mov_b64 exec, -1
  s_andn2_b64 s[44:45], s[44:45], vcc
  s_or_b64 s[52:53], s[52:53], s[44:45]
  s_waitcnt lgkmcnt(3)
  v_cmp_gt_u32 vcc, 32, v57
  v_lshl_add_u32 v29, v57, 2, v49
  s_and_b64 exec, vcc, s[46:47]
  ds_write_b32 v29, v53
  s_mov_b64 exec, -1
  s_andn2_b64 s[46:47], s[46:47], vcc
  s_or_b64 s[52:53], s[52:53], s[46:47]
  s_waitcnt lgkmcnt(3)
  v_cmp_gt_u32 vcc, 32, v58
  v_lshl_add_u32 v29, v58, 2, v50
  s_and_b64 exec, vcc, s[48:49]
  ds_write_b32 v29, v54
  s_mov_b64 exec, -1
  s_andn2_b64 s[48:49], s[48:49], vcc
  s_or_b64 s[52:53], s[52:53], s[48:49]
  s_waitcnt lgkmcnt(3)
  v_cmp_gt_u32 vcc, 32, v59
  v_lshl_add_u32 v29, v59, 2, v51
  s_and_b64 exec, vcc, s[50:51]
  ds_write_b32 v29, v55
  s_mov_b64 exec, -1
  s_andn2_b64 s[50:51], s[50:51], vcc
  s_or_b64 s[52:53], s[52:53], s[50:51]
  s_cmp_eq_u64 s[52:53], 0
  s_cbranch_scc1 K1_NOSPILL
  s_lshl_b32 s36, s2, 13
  s_add_u32 s36, s36, 6291456
  v_mov_b32 v29, 29600
  s_mov_b64 exec, s[44:45]
  s_cbranch_execz L_k1_1
  ds_add_rtn_u32 v30, v29, v45
  v_lshl_or_b32 v31, v8, 22, v52
  s_waitcnt lgkmcnt(0)
  v_lshlrev_b32 v30, 2, v30
  buffer_store_dword v31, v30, s[32:35], s36 offen
L_k1_1:
  s_mov_b64 exec, s[46:47]
  s_cbranch_execz L_k1_2
  ds_add_rtn_u32 v30, v29, v45
  v_lshl_or_b32 v31, v9, 22, v53
  s_waitcnt lgkmcnt(0)
  v_lshlrev_b32 v30, 2, v30
  buffer_store_dword v31, v30, s[32:35], s36 offen
L_k1_2:
  s_mov_b64 exec, s[48:49]
  s_cbranch_execz L_k1_3
  ds_add_rtn_u32 v30, v29, v45
  v_lshl_or_b32 v31, v10, 22, v54
  s_waitcnt lgkmcnt(0)
  v_lshlrev_b32 v30, 2, v30
  buffer_store_dword v31, v30, s[32:35], s36 offen
L_k1_3:
  s_mov_b64 exec, s[50:51]
  s_cbranch_execz L_k1_4
  ds_add_rtn_u32 v30, v29, v45
  v_lshl_or_b32 v31, v11, 22, v55
  s_waitcnt lgkmcnt(0)
  v_lshlrev_b32 v30, 2, v30
  buffer_store_dword v31, v30, s[32:35], s36 offen
L_k1_4:
  s_mov_b64 exec, -1
K1_NOSPILL:
  s_lshl_b32 s36, s2, 7
  s_add_u32 s36, s36, 1048576
  s_add_u32 s37, s36, 1605632
  s_add_u32 s38, s36, 3211264
  s_add_u32 s39, s36, 4816896
  s_waitcnt lgkmcnt(0)
  s_barrier
  ds_read_b128 v[4:7], v2
  ds_read_b128 v[8:11], v2 offset:9216
  ds_read_b128 v[12:15], v2 offset:18432
  s_waitcnt lgkmcnt(2)
  buffer_store_dwordx4 v[4:7], v3, s[32:35], s36 offen
  s_waitcnt lgkmcnt(1)
  buffer_store_dwordx4 v[8:11], v3, s[32:35], s37 offen
  s_waitcnt lgkmcnt(0)
  buffer_store_dwordx4 v[12:15], v3, s[32:35], s38 offen
  v_cmp_gt_u32 vcc, 64, v0
  s_and_saveexec_b64 s[52:53], vcc
  s_cbranch_execz K1_END
  ds_read_b128 v[16:19], v2 offset:27648
  v_mov_b32 v29, 29600
  ds_read_b32 v28, v29
  s_lshl_b32 s36, s2, 2
  s_add_u32 s36, s36, 262144
  v_mov_b32 v29, 0
  s_waitcnt lgkmcnt(1)
  buffer_store_dwordx4 v[16:19], v3, s[32:35], s39 offen
  s_waitcnt lgkmcnt(0)
  buffer_store_dword v28, v29, s[32:35], s36 offen
  s_cmp_ge_u32 s2, 4
  s_cbranch_scc1 K1_END
  s_lshl_b32 s36, s2, 10
  buffer_store_dwordx4 v[20:23], v1, s[32:35], s36 offen
K1_END:
  s_endpgm
K1_PF:
  s_cmp_ge_u32 s2, 204
  s_cbranch_scc1 K1_END
  s_load_dwordx8 s[4:11], s[0:1], 32
  s_getpc_b64 s[12:13]
K1_PFA:
  v_lshlrev_b32 v1, 7, v0
  v_cmp_gt_u32 vcc, CODE_END-K1_PFA, v1
  s_and_saveexec_b64 s[14:15], vcc
  s_cbranch_execz K1_PF2
  global_load_dword v2, v1, s[12:13]
K1_PF2:
  s_mov_b64 exec, -1
  v_and_b32 v1, 0x7fff, v1
  s_waitcnt lgkmcnt(0)
  v_cmp_gt_u32 vcc, 256, v0
  s_cbranch_vccz K1_PF3
  global_load_dword v3, v1, s[4:5]
  global_load_dword v4, v1, s[6:7]
  s_waitcnt vmcnt(0)
  s_endpgm
K1_PF3:
  global_load_dword v3, v1, s[8:9]
  global_load_dword v4, v1, s[10:11]
  s_waitcnt vmcnt(0)
  s_endpgm
.globl k2_kernel
.p2align 8
.type k2_kernel,@function
k2_kernel:
  s_load_dwordx2 s[12:13], s[0:1], 88
  s_cmp_ge_u32 s2, 200
  s_cbranch_scc1 K2_W
  v_lshrrev_b32 v1, 2, v0
  v_and_b32 v2, 3, v0
  v_lshlrev_b32 v1, 7, v1
  v_lshl_or_b32 v1, v2, 4, v1
  s_mul_i32 s14, s2, 25088
  s_add_u32 s14, s14, 1048576
  s_mul_i32 s4, s2, 171
  s_lshr_b32 s4, s4, 12
  s_mul_i32 s4, s4, 24
  s_sub_u32 s4, s2, s4
  s_cmp_ge_u32 s2, 192
  s_cselect_b32 s4, 24, s4
  v_mov_b32 v4, 0
  v_mov_b32 v5, 0
  v_mov_b32 v6, 0
  v_mov_b32 v7, 0
  v_mov_b32 v8, 0
  s_waitcnt lgkmcnt(0)
  s_mov_b32 s32, s12
  s_and_b32 s33, s13, 0xffff
  s_mov_b32 s34, 268435456
  s_mov_b32 s35, 0x00020000
  v_cmp_gt_u32 vcc, 784, v0
  s_and_saveexec_b64 s[6:7], vcc
  s_cbranch_execz K2_NOLOAD
  buffer_load_dwordx4 v[4:7], v1, s[32:35], s14 offen
  buffer_load_dwordx4 v[8:11], v1, s[32:35], s14 offen offset:64
K2_NOLOAD:
  s_mov_b64 exec, -1
  v_subrev_u32 v12, 128, v0
  v_cmp_gt_u32 vcc, 384, v12
  s_nop 1
  v_cndmask_b32 v12, 0, -1, vcc
  v_mov_b32 v13, v12
  v_mov_b32 v14, v12
  v_mov_b32 v15, v12
  v_lshlrev_b32 v2, 4, v0
  ds_write_b128 v2, v[12:15]
  s_cmp_eq_u32 s4, 24
  s_cselect_b32 s5, 0, 65535
  s_cselect_b32 s8, 32, 48
  s_cselect_b32 s9, 31, 63
  s_cselect_b32 s10, 0, 6272
  s_lshl_b32 s11, s4, 22
  s_brev_b32 s15, 1
  s_or_b32 s11, s11, s15
  s_movk_i32 s16, 0xf8
  s_movk_i32 s17, 48
  s_mov_b32 s18, 0
  v_mov_b32 v3, 1024
  s_waitcnt lgkmcnt(0)
  s_barrier
  s_waitcnt vmcnt(1)
K2_A:
  v_cmp_gt_i32 s[20:21], 0, v4
  v_bfe_u32 v12, v4, 16, 6
  v_sub_u32 v16, v4, v12
  v_cmp_gt_u16 vcc, s10, v4
  v_lshlrev_b32 v20, v16, 1
  v_and_b32 v16, 31, v16
  v_cndmask_b32 v28, 0, 4, vcc
  v_mad_u32_u24 v16, v12, s17, v16
  v_cndmask_b32_sdwa v20, v20, v20, vcc dst_sel:DWORD dst_unused:UNUSED_PAD src0_sel:DWORD src1_sel:WORD_0
  v_lshl_or_b32 v12, v12, 3, v28
  s_mov_b64 exec, s[20:21]
  ds_or_rtn_b32 v24, v12, v20
  s_mov_b64 exec, -1
  v_lshl_add_u32 v16, v28, 3, v16
  v_lshlrev_b32 v16, 1, v16
  v_lshlrev_b32 v28, 3, v4
  v_bfi_b32 v12, s16, v28, v12
  v_cmp_gt_i32 s[22:23], 0, v5
  v_bfe_u32 v13, v5, 16, 6
  v_sub_u32 v17, v5, v13
  v_cmp_gt_u16 vcc, s10, v5
  v_lshlrev_b32 v21, v17, 1
  v_and_b32 v17, 31, v17
  v_cndmask_b32 v28, 0, 4, vcc
  v_mad_u32_u24 v17, v13, s17, v17
  v_cndmask_b32_sdwa v21, v21, v21, vcc dst_sel:DWORD dst_unused:UNUSED_PAD src0_sel:DWORD src1_sel:WORD_0
  v_lshl_or_b32 v13, v13, 3, v28
  s_mov_b64 exec, s[22:23]
  ds_or_rtn_b32 v25, v13, v21
  s_mov_b64 exec, -1
  v_lshl_add_u32 v17, v28, 3, v17
  v_lshlrev_b32 v17, 1, v17
  v_lshlrev_b32 v28, 3, v5
  v_bfi_b32 v13, s16, v28, v13
  v_cmp_gt_i32 s[24:25], 0, v6
  v_bfe_u32 v14, v6, 16, 6
  v_sub_u32 v18, v6, v14
  v_cmp_gt_u16 vcc, s10, v6
  v_lshlrev_b32 v22, v18, 1
  v_and_b32 v18, 31, v18
  v_cndmask_b32 v28, 0, 4, vcc
  v_mad_u32_u24 v18, v14, s17, v18
  v_cndmask_b32_sdwa v22, v22, v22, vcc dst_sel:DWORD dst_unused:UNUSED_PAD src0_sel:DWORD src1_sel:WORD_0
  v_lshl_or_b32 v14, v14, 3, v28
  s_mov_b64 exec, s[24:25]
  ds_or_rtn_b32 v26, v14, v22
  s_mov_b64 exec, -1
  v_lshl_add_u32 v18, v28, 3, v18
  v_lshlrev_b32 v18, 1, v18
  v_lshlrev_b32 v28, 3, v6
  v_bfi_b32 v14, s16, v28, v14
  v_cmp_gt_i32 s[26:27], 0, v7
  v_bfe_u32 v15, v7, 16, 6
  v_sub_u32 v19, v7, v15
  v_cmp_gt_u16 vcc, s10, v7
  v_lshlrev_b32 v23, v19, 1
  v_and_b32 v19, 31, v19
  v_cndmask_b32 v28, 0, 4, vcc
  v_mad_u32_u24 v19, v15, s17, v19
  v_cndmask_b32_sdwa v23, v23, v23, vcc dst_sel:DWORD dst_unused:UNUSED_PAD src0_sel:DWORD src1_sel:WORD_0
  v_lshl_or_b32 v15, v15, 3, v28
  s_mov_b64 exec, s[26:27]
  ds_or_rtn_b32 v27, v15, v23
  s_mov_b64 exec, -1
  v_lshl_add_u32 v19, v28, 3, v19
  v_lshlrev_b32 v19, 1, v19
  v_lshlrev_b32 v28, 3, v7
  v_bfi_b32 v15, s16, v28, v15
  s_waitcnt lgkmcnt(3)
  v_and_b32 v24, v24, v20
  v_cmp_eq_u32 vcc, v20, v24
  s_and_b64 s[40:41], vcc, s[20:21]
  s_andn2_b64 s[20:21], s[20:21], vcc
  s_bcnt1_i32_b64 s48, s[40:41]
  s_waitcnt lgkmcnt(2)
  v_and_b32 v25, v25, v21
  v_cmp_eq_u32 vcc, v21, v25
  s_and_b64 s[42:43], vcc, s[22:23]
  s_andn2_b64 s[22:23], s[22:23], vcc
  s_bcnt1_i32_b64 s49, s[42:43]
  s_waitcnt lgkmcnt(1)
  v_and_b32 v26, v26, v22
  v_cmp_eq_u32 vcc, v22, v26
  s_and_b64 s[44:45], vcc, s[24:25]
  s_andn2_b64 s[24:25], s[24:25], vcc
  s_bcnt1_i32_b64 s50, s[44:45]
  s_waitcnt lgkmcnt(0)
  v_and_b32 v27, v27, v23
  v_cmp_eq_u32 vcc, v23, v27
  s_and_b64 s[46:47], vcc, s[26:27]
  s_andn2_b64 s[26:27], s[26:27], vcc
  s_bcnt1_i32_b64 s51, s[46:47]
  s_add_u32 s49, s49, s48
  s_add_u32 s50, s50, s49
  s_add_u32 s51, s51, s50
  v_mov_b32 v28, s51
  s_mov_b64 exec, 1
  ds_add_rtn_u32 v29, v3, v28
  s_mov_b64 exec, s[20:21]
  ds_or_b32 v12, v20 offset:512
  ds_write_b16 v16, v4 offset:2048
  s_mov_b64 exec, s[22:23]
  ds_or_b32 v13, v21 offset:512
  ds_write_b16 v17, v5 offset:2048
  s_mov_b64 exec, s[24:25]
  ds_or_b32 v14, v22 offset:512
  ds_write_b16 v18, v6 offset:2048
  s_mov_b64 exec, s[26:27]
  ds_or_b32 v15, v23 offset:512
  ds_write_b16 v19, v7 offset:2048
  s_mov_b64 exec, -1
  v_mbcnt_lo_u32_b32 v24, s40, 0
  v_mbcnt_hi_u32_b32 v24, s41, v24
  v_mov_b32 v25, s48
  v_mbcnt_lo_u32_b32 v25, s42, v25
  v_mbcnt_hi_u32_b32 v25, s43, v25
  v_mov_b32 v26, s49
  v_mbcnt_lo_u32_b32 v26, s44, v26
  v_mbcnt_hi_u32_b32 v26, s45, v26
  v_mov_b32 v27, s50
  v_mbcnt_lo_u32_b32 v27, s46, v27
  v_mbcnt_hi_u32_b32 v27, s47, v27
  s_waitcnt lgkmcnt(8)
  v_readfirstlane_b32 s52, v29
  s_nop 1
  v_add_lshl_u32 v24, v24, s52, 2
  v_add_lshl_u32 v25, v25, s52, 2
  v_add_lshl_u32 v26, v26, s52, 2
  v_add_lshl_u32 v27, v27, s52, 2
  s_mov_b64 exec, s[40:41]
  ds_write_b32 v24, v4 offset:8320
  s_mov_b64 exec, s[42:43]
  ds_write_b32 v25, v5 offset:8320
  s_mov_b64 exec, s[44:45]
  ds_write_b32 v26, v6 offset:8320
  s_mov_b64 exec, s[46:47]
  ds_write_b32 v27, v7 offset:8320
  s_mov_b64 exec, -1
  s_cmp_lg_u32 s18, 0
  s_cbranch_scc1 K2_ADONE
  s_waitcnt vmcnt(0)
  v_cmp_gt_i32 vcc, 0, v8
  s_cbranch_vccz K2_ADONE
  s_mov_b32 s18, 1
  v_cndmask_b32 v4, 0, v8, vcc
  v_cndmask_b32 v5, 0, v9, vcc
  v_cndmask_b32 v6, 0, v10, vcc
  v_cndmask_b32 v7, 0, v11, vcc
  s_branch K2_A
K2_ADONE:
  s_cmp_ge_u32 s2, 196
  s_cbranch_scc1 K2_NOFILL
  v_mov_b32 v30, -1
  v_mov_b32 v31, -1
  v_mov_b32 v32, -1
  v_mov_b32 v33, -1
  s_lshl_b32 s26, s2, 14
  s_add_u32 s26, s26, 36765696
  buffer_store_dwordx4 v[30:33], v2, s[32:35], s26 offen sc1
K2_NOFILL:
  v_lshlrev_b32 v2, 2, v0
  v_mov_b32 v1, v0
  s_waitcnt lgkmcnt(0)
  s_barrier
  ds_read_b32 v5, v3
K2_BATCH:
  ds_read_b32 v4, v2 offset:8320
  s_waitcnt lgkmcnt(0)
  v_cmp_lt_u32 vcc, v1, v5
  s_and_b64 exec, exec, vcc
  s_cbranch_execz K2_FIN
  s_mov_b64 s[20:21], exec
  v_bfe_u32 v8, v4, 16, 6
  v_lshlrev_b32 v6, 3, v8
  v_lshlrev_b32 v7, 3, v4
  v_bfi_b32 v7, s16, v7, v6
  ds_read_b64 v[10:11], v6
  ds_read_b64 v[12:13], v7 offset:512
  s_mov_b32 s22, 0x9e3779b1
  v_xor_b32 v9, v4, v2
  v_mul_lo_u32 v9, v9, s22
  v_mul_u32_u24 v8, 96, v8
  v_cmp_gt_u16 s[28:29], s10, v4
  v_mov_b32 v27, s5
  v_mov_b32 v35, -1
  v_cndmask_b32 v28, 32, 16, s[28:29]
  v_cndmask_b32 v34, -1, 0, s[28:29]
  v_cndmask_b32 v27, 0, v27, s[28:29]
  v_mul_u32_u24_sdwa v26, v9, v28 dst_sel:DWORD dst_unused:UNUSED_PAD src0_sel:BYTE_3 src1_sel:DWORD
  v_lshrrev_b32 v26, 8, v26
  v_lshlrev_b64 v[16:17], v26, v[34:35]
  s_waitcnt lgkmcnt(0)
  v_bitop3_b32 v14, v10, v12, v34 bitop3:0x02
  v_bitop3_b32 v15, v11, v13, v27 bitop3:0x02
  v_and_b32 v16, v16, v14
  v_and_b32 v17, v17, v15
  v_cmp_ne_u64 vcc, 0, v[16:17]
  s_nop 1
  v_cndmask_b32 v14, v14, v16, vcc
  v_cndmask_b32 v15, v15, v17, vcc
  v_sub_co_u32 v16, vcc, 0, v14
  s_nop 1
  v_subb_co_u32 v17, vcc, 0, v15, vcc
  v_and_b32 v18, v16, v14
  v_and_b32 v19, v17, v15
  ds_or_rtn_b64 v[10:11], v6, v[18:19]
  ds_or_rtn_b64 v[12:13], v7, v[18:19] offset:512
  s_waitcnt lgkmcnt(0)
  v_bitop3_b32 v20, v18, v10, v12 bitop3:0x10
  v_bitop3_b32 v21, v19, v11, v13 bitop3:0x10
  v_cmpx_eq_u64 vcc, 0, v[20:21]
  s_cbranch_execz K2_RDONE
  v_bitop3_b32 v22, v18, v10, v12 bitop3:0x20
  v_bitop3_b32 v23, v19, v11, v13 bitop3:0x20
  v_bitop3_b32 v24, v18, v12, v10 bitop3:0x20
  v_bitop3_b32 v25, v19, v13, v11 bitop3:0x20
  ds_xor_b64 v6, v[22:23]
  ds_xor_b64 v7, v[24:25] offset:512
  v_mul_u32_u24_sdwa v26, v9, v28 dst_sel:DWORD dst_unused:UNUSED_PAD src0_sel:BYTE_2 src1_sel:DWORD
  v_lshrrev_b32 v26, 8, v26
  v_lshlrev_b64 v[16:17], v26, v[34:35]
  s_waitcnt lgkmcnt(0)
  v_bitop3_b32 v14, v10, v12, v34 bitop3:0x02
  v_bitop3_b32 v15, v11, v13, v27 bitop3:0x02
  v_and_b32 v16, v16, v14
  v_and_b32 v17, v17, v15
  v_cmp_ne_u64 vcc, 0, v[16:17]
  s_nop 1
  v_cndmask_b32 v14, v14, v16, vcc
  v_cndmask_b32 v15, v15, v17, vcc
  v_sub_co_u32 v16, vcc, 0, v14
  s_nop 1
  v_subb_co_u32 v17, vcc, 0, v15, vcc
  v_and_b32 v18, v16, v14
  v_and_b32 v19, v17, v15
  ds_or_rtn_b64 v[10:11], v6, v[18:19]
  ds_or_rtn_b64 v[12:13], v7, v[18:19] offset:512
  s_waitcnt lgkmcnt(0)
  v_bitop3_b32 v20, v18, v10, v12 bitop3:0x10
  v_bitop3_b32 v21, v19, v11, v13 bitop3:0x10
  v_cmpx_eq_u64 vcc, 0, v[20:21]
  s_cbranch_execz K2_RDONE
  v_bitop3_b32 v22, v18, v10, v12 bitop3:0x20
  v_bitop3_b32 v23, v19, v11, v13 bitop3:0x20
  v_bitop3_b32 v24, v18, v12, v10 bitop3:0x20
  v_bitop3_b32 v25, v19, v13, v11 bitop3:0x20
  ds_xor_b64 v6, v[22:23]
  ds_xor_b64 v7, v[24:25] offset:512
  v_mul_u32_u24_sdwa v26, v9, v28 dst_sel:DWORD dst_unused:UNUSED_PAD src0_sel:BYTE_1 src1_sel:DWORD
  v_lshrrev_b32 v26, 8, v26
  v_lshlrev_b64 v[16:17], v26, v[34:35]
  s_waitcnt lgkmcnt(0)
  v_bitop3_b32 v14, v10, v12, v34 bitop3:0x02
  v_bitop3_b32 v15, v11, v13, v27 bitop3:0x02
  v_and_b32 v16, v16, v14
  v_and_b32 v17, v17, v15
  v_cmp_ne_u64 vcc, 0, v[16:17]
  s_nop 1
  v_cndmask_b32 v14, v14, v16, vcc
  v_cndmask_b32 v15, v15, v17, vcc
  v_sub_co_u32 v16, vcc, 0, v14
  s_nop 1
  v_subb_co_u32 v17, vcc, 0, v15, vcc
  v_and_b32 v18, v16, v14
  v_and_b32 v19, v17, v15
  ds_or_rtn_b64 v[10:11], v6, v[18:19]
  ds_or_rtn_b64 v[12:13], v7, v[18:19] offset:512
  s_waitcnt lgkmcnt(0)
  v_bitop3_b32 v20, v18, v10, v12 bitop3:0x10
  v_bitop3_b32 v21, v19, v11, v13 bitop3:0x10
  v_cmpx_eq_u64 vcc, 0, v[20:21]
  s_cbranch_execz K2_RDONE
  v_bitop3_b32 v22, v18, v10, v12 bitop3:0x20
  v_bitop3_b32 v23, v19, v11, v13 bitop3:0x20
  v_bitop3_b32 v24, v18, v12, v10 bitop3:0x20
  v_bitop3_b32 v25, v19, v13, v11 bitop3:0x20
  ds_xor_b64 v6, v[22:23]
  ds_xor_b64 v7, v[24:25] offset:512
  v_cndmask_b32 v28, 32, 48, s[28:29]
  v_mul_u32_u24_sdwa v26, v9, v28 dst_sel:DWORD dst_unused:UNUSED_PAD src0_sel:BYTE_0 src1_sel:DWORD
  v_lshrrev_b32 v26, 8, v26
  v_lshlrev_b64 v[16:17], v26, -1
  s_waitcnt lgkmcnt(0)
  v_bitop3_b32 v14, v10, v12, -1 bitop3:0x02
  v_bitop3_b32 v15, v11, v13, v27 bitop3:0x02
  v_and_b32 v16, v16, v14
  v_and_b32 v17, v17, v15
  v_cmp_ne_u64 vcc, 0, v[16:17]
  s_nop 1
  v_cndmask_b32 v14, v14, v16, vcc
  v_cndmask_b32 v15, v15, v17, vcc
  v_sub_co_u32 v16, vcc, 0, v14
  s_nop 1
  v_subb_co_u32 v17, vcc, 0, v15, vcc
  v_and_b32 v18, v16, v14
  v_and_b32 v19, v17, v15
  ds_or_rtn_b64 v[10:11], v6, v[18:19]
  ds_or_rtn_b64 v[12:13], v7, v[18:19] offset:512
  s_waitcnt lgkmcnt(0)
  v_bitop3_b32 v20, v18, v10, v12 bitop3:0x10
  v_bitop3_b32 v21, v19, v11, v13 bitop3:0x10
  v_cmpx_eq_u64 vcc, 0, v[20:21]
  s_cbranch_execz K2_RDONE
  v_bitop3_b32 v22, v18, v10, v12 bitop3:0x20
  v_bitop3_b32 v23, v19, v11, v13 bitop3:0x20
  v_bitop3_b32 v24, v18, v12, v10 bitop3:0x20
  v_bitop3_b32 v25, v19, v13, v11 bitop3:0x20
  ds_xor_b64 v6, v[22:23]
  ds_xor_b64 v7, v[24:25] offset:512
  v_mul_lo_u32 v9, v9, s22
  v_mul_u32_u24_sdwa v26, v9, v28 dst_sel:DWORD dst_unused:UNUSED_PAD src0_sel:BYTE_3 src1_sel:DWORD
  v_lshrrev_b32 v26, 8, v26
  v_lshlrev_b64 v[16:17], v26, -1
  s_waitcnt lgkmcnt(0)
  v_bitop3_b32 v14, v10, v12, -1 bitop3:0x02
  v_bitop3_b32 v15, v11, v13, v27 bitop3:0x02
  v_and_b32 v16, v16, v14
  v_and_b32 v17, v17, v15
  v_cmp_ne_u64 vcc, 0, v[16:17]
  s_nop 1
  v_cndmask_b32 v14, v14, v16, vcc
  v_cndmask_b32 v15, v15, v17, vcc
  v_sub_co_u32 v16, vcc, 0, v14
  s_nop 1
  v_subb_co_u32 v17, vcc, 0, v15, vcc
  v_and_b32 v18, v16, v14
  v_and_b32 v19, v17, v15
  ds_or_rtn_b64 v[10:11], v6, v[18:19]
  ds_or_rtn_b64 v[12:13], v7, v[18:19] offset:512
  s_waitcnt lgkmcnt(0)
  v_bitop3_b32 v20, v18, v10, v12 bitop3:0x10
  v_bitop3_b32 v21, v19, v11, v13 bitop3:0x10
  v_cmpx_eq_u64 vcc, 0, v[20:21]
  s_cbranch_execz K2_RDONE
  v_bitop3_b32 v22, v18, v10, v12 bitop3:0x20
  v_bitop3_b32 v23, v19, v11, v13 bitop3:0x20
  v_bitop3_b32 v24, v18, v12, v10 bitop3:0x20
  v_bitop3_b32 v25, v19, v13, v11 bitop3:0x20
  ds_xor_b64 v6, v[22:23]
  ds_xor_b64 v7, v[24:25] offset:512
  v_mul_u32_u24_sdwa v26, v9, v28 dst_sel:DWORD dst_unused:UNUSED_PAD src0_sel:BYTE_2 src1_sel:DWORD
  v_lshrrev_b32 v26, 8, v26
  v_lshlrev_b64 v[16:17], v26, -1
  s_waitcnt lgkmcnt(0)
  v_bitop3_b32 v14, v10, v12, -1 bitop3:0x02
  v_bitop3_b32 v15, v11, v13, v27 bitop3:0x02
  v_and_b32 v16, v16, v14
  v_and_b32 v17, v17, v15
  v_cmp_ne_u64 vcc, 0, v[16:17]
  s_nop 1
  v_cndmask_b32 v14, v14, v16, vcc
  v_cndmask_b32 v15, v15, v17, vcc
  v_sub_co_u32 v16, vcc, 0, v14
  s_nop 1
  v_subb_co_u32 v17, vcc, 0, v15, vcc
  v_and_b32 v18, v16, v14
  v_and_b32 v19, v17, v15
  ds_or_rtn_b64 v[10:11], v6, v[18:19]
  ds_or_rtn_b64 v[12:13], v7, v[18:19] offset:512
  s_waitcnt lgkmcnt(0)
  v_bitop3_b32 v20, v18, v10, v12 bitop3:0x10
  v_bitop3_b32 v21, v19, v11, v13 bitop3:0x10
  v_cmpx_eq_u64 vcc, 0, v[20:21]
  s_cbranch_execz K2_RDONE
  v_bitop3_b32 v22, v18, v10, v12 bitop3:0x20
  v_bitop3_b32 v23, v19, v11, v13 bitop3:0x20
  v_bitop3_b32 v24, v18, v12, v10 bitop3:0x20
  v_bitop3_b32 v25, v19, v13, v11 bitop3:0x20
  ds_xor_b64 v6, v[22:23]
  ds_xor_b64 v7, v[24:25] offset:512
  v_cndmask_b32 v28, 32, 0, s[28:29]
K2_LEFT:
  v_mul_u32_u24_sdwa v26, v9, v28 dst_sel:DWORD dst_unused:UNUSED_PAD src0_sel:BYTE_0 src1_sel:DWORD
  v_lshrrev_b32 v26, 8, v26
  v_lshlrev_b64 v[16:17], v26, v[34:35]
  s_waitcnt lgkmcnt(0)
  v_not_b32 v14, v10
  v_bfi_b32 v15, v11, 0, v27
  v_and_b32 v16, v16, v14
  v_and_b32 v17, v17, v15
  v_cmp_ne_u64 vcc, 0, v[16:17]
  s_nop 1
  v_cndmask_b32 v14, v14, v16, vcc
  v_cndmask_b32 v15, v15, v17, vcc
  v_sub_co_u32 v16, vcc, 0, v14
  s_nop 1
  v_subb_co_u32 v17, vcc, 0, v15, vcc
  v_and_b32 v18, v16, v14
  v_and_b32 v19, v17, v15
  v_cmp_eq_u64 vcc, 0, v[18:19]
  s_cbranch_vccz K2_LEFT2
  s_andn2_b64 s[20:21], s[20:21], vcc
  s_andn2_b64 s[24:25], exec, vcc
  s_mov_b64 exec, vcc
  v_mov_b32 v22, 1
  v_mov_b32 v23, 8192
  ds_add_rtn_u32 v22, v23, v22
  v_bfe_u32 v23, v4, 16, 6
  v_and_b32 v23, s9, v23
  v_lshlrev_b32 v23, 16, v23
  v_add_u32 v23, s11, v23
  v_and_b32 v24, 0xffff, v4
  v_or_b32 v23, v23, v24
  s_mul_i32 s26, s2, 25088
  s_add_u32 s26, s26, 10485760
  s_waitcnt lgkmcnt(0)
  v_lshlrev_b32 v22, 2, v22
  buffer_store_dword v23, v22, s[32:35], s26 offen
  v_cmpx_gt_u32 vcc, 64, v22
  ds_write_b32 v22, v23 offset:8256
  s_mov_b64 exec, s[24:25]
  s_cbranch_execz K2_RDONE
K2_LEFT2:
  ds_or_rtn_b64 v[10:11], v6, v[18:19]
  s_waitcnt lgkmcnt(0)
  v_bfi_b32 v20, v10, 0, v18
  v_bfi_b32 v21, v11, 0, v19
  v_cmpx_eq_u64 vcc, 0, v[20:21]
  s_cbranch_execnz K2_LEFT
K2_RDONE:
  s_mov_b64 exec, s[20:21]
  v_ffbl_b32 v20, v20
  v_ffbl_b32 v21, v21
  v_or_b32 v21, 32, v21
  v_min_u32 v20, v20, v21
  v_lshl_add_u32 v20, v20, 1, v8
  ds_write_b16 v20, v4 offset:2048
  s_mov_b64 exec, -1
  v_add_u32 v1, 0x400, v1
  v_add_u32 v2, 0x1000, v2
  v_cmp_lt_u32 vcc, v1, v5
  s_cbranch_vccnz K2_BATCH
K2_FIN:
  s_mov_b64 exec, -1
  v_and_b32 v1, 63, v0
  v_mul_u32_u24 v1, 96, v1
  v_lshrrev_b32 v2, 6, v0
  v_lshl_add_u32 v1, v2, 4, v1
  v_lshlrev_b32 v2, 4, v0
  v_cmp_le_u32 vcc, 384, v0
  s_nop 1
  v_cndmask_b32 v1, v1, v2, vcc
  s_mul_i32 s26, s2, 6272
  s_add_u32 s26, s26, 8388608
  v_cmp_gt_u32 vcc, 392, v0
  s_waitcnt lgkmcnt(0)
  s_barrier
  s_and_saveexec_b64 s[6:7], vcc
  s_cbranch_execz K2_END
  ds_read_b128 v[4:7], v1 offset:2048
  s_waitcnt lgkmcnt(0)
  buffer_store_dwordx4 v[4:7], v2, s[32:35], s26 offen
K2_END:
  s_endpgm
K2_W:
  s_cmp_ge_u32 s2, 202
  s_cbranch_scc1 K2_END
  s_and_b32 s3, s2, 1
  s_lshl_b32 s10, s3, 4
  s_add_u32 s10, s10, 32
  s_load_dwordx4 s[4:7], s[0:1], s10
  s_load_dwordx2 s[8:9], s[0:1], 64
  v_and_b32 v1, 63, v0
  v_lshrrev_b32 v2, 6, v0
  v_and_b32 v3, 15, v0
  v_bfe_u32 v4, v0, 4, 2
  v_readfirstlane_b32 s10, v2
  v_lshrrev_b32 v7, 8, v0
  v_lshl_or_b32 v7, v7, 2, v4
  v_xor_b32 v7, v7, v3
  v_lshlrev_b32 v7, 4, v7
  v_lshl_or_b32 v7, v4, 8, v7
  s_lshl_b32 s10, s10, 11
  s_add_u32 m0, s10, 12288
  s_waitcnt lgkmcnt(0)
  s_mov_b32 s16, s4
  s_and_b32 s17, s5, 0xffff
  s_mov_b32 s18, 32768
  s_mov_b32 s19, 0x00020000
  s_mov_b32 s20, s6
  s_and_b32 s21, s7, 0xffff
  s_mov_b32 s22, 32768
  s_mov_b32 s23, 0x00020000
  s_mov_b32 s24, s8
  s_and_b32 s25, s9, 0xffff
  s_mov_b32 s26, 256
  s_mov_b32 s27, 0x00020000
  s_mov_b32 s32, s12
  s_and_b32 s33, s13, 0xffff
  s_mov_b32 s34, 268435456
  s_mov_b32 s35, 0x00020000
  buffer_load_dwordx4 v7, s[20:23], s10 offen offset:0 lds
  buffer_load_dwordx4 v7, s[20:23], s10 offen offset:1024 lds
  s_add_u32 m0, s10, 45056
  v_lshrrev_b32 v2, 7, v0
  v_lshrrev_b32 v5, 2, v3
  v_and_b32 v6, 3, v3
  buffer_load_dwordx4 v7, s[16:19], s10 offen offset:0 lds
  buffer_load_dwordx4 v7, s[16:19], s10 offen offset:1024 lds
  v_lshl_or_b32 v5, v5, 5, v6
  v_lshl_add_u32 v8, v2, 2, v5
  v_lshlrev_b32 v7, 1, v8
  buffer_load_ushort v13, v7, s[24:27], 0 offen
  v_xor_b32 v6, v4, v3
  v_lshlrev_b32 v6, 4, v6
  v_lshl_or_b32 v6, v5, 8, v6
  v_bfe_u32 v9, v0, 6, 1
  v_lshl_add_u32 v96, v9, 12, v6
  v_add_u32 v96, 45056, v96
  v_lshl_add_u32 v100, v2, 10, v6
  s_cmp_eq_u32 s3, 0
  s_cbranch_scc1 K2_WA
  v_lshrrev_b32 v10, 2, v3
  v_lshrrev_b32 v11, 1, v2
  v_xor_b32 v11, v11, v10
  v_and_b32 v12, 3, v3
  v_lshl_or_b32 v11, v12, 2, v11
  v_lshl_or_b32 v10, v4, 3, v10
  v_lshl_or_b32 v10, v10, 4, v11
  v_and_b32 v11, 1, v2
  v_lshl_or_b32 v10, v10, 1, v11
  v_lshlrev_b32 v100, 3, v10
K2_WA:
  v_xor_b32 v97, 64, v96
  v_xor_b32 v101, 64, v100
  v_xor_b32 v98, 128, v96
  v_xor_b32 v102, 128, v100
  v_xor_b32 v99, 192, v96
  v_xor_b32 v103, 192, v100
  s_waitcnt vmcnt(1) lgkmcnt(0)
  s_barrier
  s_cmp_eq_u32 s3, 0
  s_cbranch_scc0 K2_WV1
  ds_read_b128 v[32:35], v100 offset:12288
  ds_read_b128 v[36:39], v101 offset:12288
  ds_read_b128 v[40:43], v102 offset:12288
  ds_read_b128 v[44:47], v103 offset:12288
  s_branch K2_WA2
K2_WV1:
  ds_read_b64_tr_b16 v[32:33], v100 offset:12288
  ds_read_b64_tr_b16 v[34:35], v100 offset:13312
  ds_read_b64_tr_b16 v[36:37], v101 offset:20480
  ds_read_b64_tr_b16 v[38:39], v101 offset:21504
  ds_read_b64_tr_b16 v[40:41], v102 offset:28672
  ds_read_b64_tr_b16 v[42:43], v102 offset:29696
  ds_read_b64_tr_b16 v[44:45], v103 offset:36864
  ds_read_b64_tr_b16 v[46:47], v103 offset:37888
K2_WA2:
  ds_read_b128 v[48:51], v96 offset:0
  ds_read_b128 v[52:55], v97 offset:0
  ds_read_b128 v[56:59], v98 offset:0
  ds_read_b128 v[60:63], v99 offset:0
  s_waitcnt lgkmcnt(4)
  ds_read_b128 v[64:67], v96 offset:1024
  ds_read_b128 v[68:71], v97 offset:1024
  ds_read_b128 v[72:75], v98 offset:1024
  ds_read_b128 v[76:79], v99 offset:1024
  ds_read_b128 v[80:83], v96 offset:2048
  ds_read_b128 v[84:87], v97 offset:2048
  ds_read_b128 v[88:91], v98 offset:2048
  ds_read_b128 v[92:95], v99 offset:2048
  s_waitcnt lgkmcnt(8)
  v_mfma_f32_16x16x32_bf16 v[16:19], v[48:51], v[32:35], 0
  v_mfma_f32_16x16x32_bf16 v[16:19], v[52:55], v[36:39], v[16:19]
  v_mfma_f32_16x16x32_bf16 v[16:19], v[56:59], v[40:43], v[16:19]
  v_mfma_f32_16x16x32_bf16 v[16:19], v[60:63], v[44:47], v[16:19]
  ds_read_b128 v[48:51], v96 offset:3072
  ds_read_b128 v[52:55], v97 offset:3072
  ds_read_b128 v[56:59], v98 offset:3072
  ds_read_b128 v[60:63], v99 offset:3072
  s_waitcnt lgkmcnt(8)
  v_mfma_f32_16x16x32_bf16 v[20:23], v[64:67], v[32:35], 0
  v_mfma_f32_16x16x32_bf16 v[20:23], v[68:71], v[36:39], v[20:23]
  v_mfma_f32_16x16x32_bf16 v[20:23], v[72:75], v[40:43], v[20:23]
  v_mfma_f32_16x16x32_bf16 v[20:23], v[76:79], v[44:47], v[20:23]
  s_waitcnt lgkmcnt(4)
  v_mfma_f32_16x16x32_bf16 v[24:27], v[80:83], v[32:35], 0
  v_mfma_f32_16x16x32_bf16 v[24:27], v[84:87], v[36:39], v[24:27]
  v_mfma_f32_16x16x32_bf16 v[24:27], v[88:91], v[40:43], v[24:27]
  v_mfma_f32_16x16x32_bf16 v[24:27], v[92:95], v[44:47], v[24:27]
  s_waitcnt lgkmcnt(0)
  v_mfma_f32_16x16x32_bf16 v[28:31], v[48:51], v[32:35], 0
  v_mfma_f32_16x16x32_bf16 v[28:31], v[52:55], v[36:39], v[28:31]
  v_mfma_f32_16x16x32_bf16 v[28:31], v[56:59], v[40:43], v[28:31]
  v_mfma_f32_16x16x32_bf16 v[28:31], v[60:63], v[44:47], v[28:31]
  s_waitcnt vmcnt(0)
  s_mov_b32 s11, 0x418293ee
  s_cmp_eq_u32 s3, 0
  s_cselect_b32 s11, s11, 0x413504f3
  v_mul_f32 v16, s11, v16
  v_mul_f32 v17, s11, v17
  v_mul_f32 v18, s11, v18
  v_mul_f32 v19, s11, v19
  v_mul_f32 v20, s11, v20
  v_mul_f32 v21, s11, v21
  v_mul_f32 v22, s11, v22
  v_mul_f32 v23, s11, v23
  v_mul_f32 v24, s11, v24
  v_mul_f32 v25, s11, v25
  v_mul_f32 v26, s11, v26
  v_mul_f32 v27, s11, v27
  v_mul_f32 v28, s11, v28
  v_mul_f32 v29, s11, v29
  v_mul_f32 v30, s11, v30
  v_mul_f32 v31, s11, v31
  v_add_f32 v14, v16, v17
  v_add_f32 v15, v18, v19
  v_add_f32 v14, v14, v20
  v_add_f32 v15, v15, v21
  v_add_f32 v14, v14, v22
  v_add_f32 v15, v15, v23
  v_add_f32 v14, v14, v24
  v_add_f32 v15, v15, v25
  v_add_f32 v14, v14, v26
  v_add_f32 v15, v15, v27
  v_add_f32 v14, v14, v28
  v_add_f32 v15, v15, v29
  v_add_f32 v14, v14, v30
  v_add_f32 v15, v15, v31
  v_add_f32 v14, v14, v15
  v_lshlrev_b32 v11, 3, v8
  v_lshl_or_b32 v12, v4, 1, v9
  v_lshl_or_b32 v12, v12, 4, v3
  v_lshlrev_b32 v12, 5, v12
  v_lshl_or_b32 v10, v2, 2, v12
  v_lshl_or_b32 v6, v9, 2, v11
  v_lshlrev_b32 v13, 16, v13
  s_mov_b32 s36, 0xaaaaaaaa
  s_mov_b32 s37, 0xaaaaaaaa
  s_mov_b32 s38, 0xcccccccc
  s_mov_b32 s39, 0xcccccccc
  v_mov_b32 v15, v14
  s_nop 1
  v_permlane16_swap_b32 v15, v14
  v_add_f32 v14, v14, v15
  v_mov_b32 v15, v14
  s_nop 1
  v_permlane32_swap_b32 v15, v14
  v_add_f32 v14, v14, v15
  ds_write_b32 v6, v14 offset:0
  v_add_f32_dpp v48, v16, v16 row_ror:8 row_mask:0xf bank_mask:0x3
  v_add_f32_dpp v49, v17, v17 row_ror:8 row_mask:0xf bank_mask:0x3
  v_add_f32_dpp v50, v18, v18 row_ror:8 row_mask:0xf bank_mask:0x3
  v_add_f32_dpp v51, v19, v19 row_ror:8 row_mask:0xf bank_mask:0x3
  v_add_f32_dpp v52, v20, v20 row_ror:8 row_mask:0xf bank_mask:0x3
  v_add_f32_dpp v53, v21, v21 row_ror:8 row_mask:0xf bank_mask:0x3
  v_add_f32_dpp v54, v22, v22 row_ror:8 row_mask:0xf bank_mask:0x3
  v_add_f32_dpp v55, v23, v23 row_ror:8 row_mask:0xf bank_mask:0x3
  v_add_f32_dpp v48, v24, v24 row_ror:8 row_mask:0xf bank_mask:0xc
  v_add_f32_dpp v49, v25, v25 row_ror:8 row_mask:0xf bank_mask:0xc
  v_add_f32_dpp v50, v26, v26 row_ror:8 row_mask:0xf bank_mask:0xc
  v_add_f32_dpp v51, v27, v27 row_ror:8 row_mask:0xf bank_mask:0xc
  v_add_f32_dpp v52, v28, v28 row_ror:8 row_mask:0xf bank_mask:0xc
  v_add_f32_dpp v53, v29, v29 row_ror:8 row_mask:0xf bank_mask:0xc
  v_add_f32_dpp v54, v30, v30 row_ror:8 row_mask:0xf bank_mask:0xc
  v_add_f32_dpp v55, v31, v31 row_ror:8 row_mask:0xf bank_mask:0xc
  v_add_f32_dpp v48, v48, v48 row_half_mirror row_mask:0xf bank_mask:0x5
  v_add_f32_dpp v49, v49, v49 row_half_mirror row_mask:0xf bank_mask:0x5
  v_add_f32_dpp v50, v50, v50 row_half_mirror row_mask:0xf bank_mask:0x5
  v_add_f32_dpp v51, v51, v51 row_half_mirror row_mask:0xf bank_mask:0x5
  v_add_f32_dpp v48, v52, v52 row_half_mirror row_mask:0xf bank_mask:0xa
  v_add_f32_dpp v49, v53, v53 row_half_mirror row_mask:0xf bank_mask:0xa
  v_add_f32_dpp v50, v54, v54 row_half_mirror row_mask:0xf bank_mask:0xa
  v_add_f32_dpp v51, v55, v55 row_half_mirror row_mask:0xf bank_mask:0xa
  v_add_f32_dpp v48, v48, v48 quad_perm:[2,3,0,1] row_mask:0xf bank_mask:0xf
  v_add_f32_dpp v49, v49, v49 quad_perm:[2,3,0,1] row_mask:0xf bank_mask:0xf
  v_add_f32_dpp v50, v50, v50 quad_perm:[2,3,0,1] row_mask:0xf bank_mask:0xf
  v_add_f32_dpp v51, v51, v51 quad_perm:[2,3,0,1] row_mask:0xf bank_mask:0xf
  v_cndmask_b32 v48, v48, v50, s[38:39]
  v_cndmask_b32 v49, v49, v51, s[38:39]
  s_nop 0
  v_add_f32_dpp v48, v48, v48 quad_perm:[1,0,3,2] row_mask:0xf bank_mask:0xf
  v_add_f32_dpp v49, v49, v49 quad_perm:[1,0,3,2] row_mask:0xf bank_mask:0xf
  v_cndmask_b32 v48, v48, v49, s[36:37]
  ds_write_b32 v10, v48 offset:4096
  s_cmp_eq_u32 s3, 0
  s_cbranch_scc1 K2_WB
  v_mul_f32 v64, v16, v13
  v_mul_f32 v65, v17, v13
  v_mul_f32 v66, v18, v13
  v_mul_f32 v67, v19, v13
  v_mul_f32 v68, v20, v13
  v_mul_f32 v69, v21, v13
  v_mul_f32 v70, v22, v13
  v_mul_f32 v71, v23, v13
  v_mul_f32 v72, v24, v13
  v_mul_f32 v73, v25, v13
  v_mul_f32 v74, v26, v13
  v_mul_f32 v75, v27, v13
  v_mul_f32 v76, v28, v13
  v_mul_f32 v77, v29, v13
  v_mul_f32 v78, v30, v13
  v_mul_f32 v79, v31, v13
  v_add_f32_dpp v56, v64, v64 row_ror:8 row_mask:0xf bank_mask:0x3
  v_add_f32_dpp v57, v65, v65 row_ror:8 row_mask:0xf bank_mask:0x3
  v_add_f32_dpp v58, v66, v66 row_ror:8 row_mask:0xf bank_mask:0x3
  v_add_f32_dpp v59, v67, v67 row_ror:8 row_mask:0xf bank_mask:0x3
  v_add_f32_dpp v60, v68, v68 row_ror:8 row_mask:0xf bank_mask:0x3
  v_add_f32_dpp v61, v69, v69 row_ror:8 row_mask:0xf bank_mask:0x3
  v_add_f32_dpp v62, v70, v70 row_ror:8 row_mask:0xf bank_mask:0x3
  v_add_f32_dpp v63, v71, v71 row_ror:8 row_mask:0xf bank_mask:0x3
  v_add_f32_dpp v56, v72, v72 row_ror:8 row_mask:0xf bank_mask:0xc
  v_add_f32_dpp v57, v73, v73 row_ror:8 row_mask:0xf bank_mask:0xc
  v_add_f32_dpp v58, v74, v74 row_ror:8 row_mask:0xf bank_mask:0xc
  v_add_f32_dpp v59, v75, v75 row_ror:8 row_mask:0xf bank_mask:0xc
  v_add_f32_dpp v60, v76, v76 row_ror:8 row_mask:0xf bank_mask:0xc
  v_add_f32_dpp v61, v77, v77 row_ror:8 row_mask:0xf bank_mask:0xc
  v_add_f32_dpp v62, v78, v78 row_ror:8 row_mask:0xf bank_mask:0xc
  v_add_f32_dpp v63, v79, v79 row_ror:8 row_mask:0xf bank_mask:0xc
  v_add_f32_dpp v56, v56, v56 row_half_mirror row_mask:0xf bank_mask:0x5
  v_add_f32_dpp v57, v57, v57 row_half_mirror row_mask:0xf bank_mask:0x5
  v_add_f32_dpp v58, v58, v58 row_half_mirror row_mask:0xf bank_mask:0x5
  v_add_f32_dpp v59, v59, v59 row_half_mirror row_mask:0xf bank_mask:0x5
  v_add_f32_dpp v56, v60, v60 row_half_mirror row_mask:0xf bank_mask:0xa
  v_add_f32_dpp v57, v61, v61 row_half_mirror row_mask:0xf bank_mask:0xa
  v_add_f32_dpp v58, v62, v62 row_half_mirror row_mask:0xf bank_mask:0xa
  v_add_f32_dpp v59, v63, v63 row_half_mirror row_mask:0xf bank_mask:0xa
  v_add_f32_dpp v56, v56, v56 quad_perm:[2,3,0,1] row_mask:0xf bank_mask:0xf
  v_add_f32_dpp v57, v57, v57 quad_perm:[2,3,0,1] row_mask:0xf bank_mask:0xf
  v_add_f32_dpp v58, v58, v58 quad_perm:[2,3,0,1] row_mask:0xf bank_mask:0xf
  v_add_f32_dpp v59, v59, v59 quad_perm:[2,3,0,1] row_mask:0xf bank_mask:0xf
  v_cndmask_b32 v56, v56, v58, s[38:39]
  v_cndmask_b32 v57, v57, v59, s[38:39]
  s_nop 0
  v_add_f32_dpp v56, v56, v56 quad_perm:[1,0,3,2] row_mask:0xf bank_mask:0xf
  v_add_f32_dpp v57, v57, v57 quad_perm:[1,0,3,2] row_mask:0xf bank_mask:0xf
  v_cndmask_b32 v56, v56, v57, s[36:37]
  ds_write_b32 v10, v56 offset:8192
  v_lshl_or_b32 v12, v2, 12, v12
  v_lshlrev_b32 v15, 2, v1
  buffer_load_dword v36, v15, s[24:27], 0 offen
K2_WB:
  v_lshlrev_b32 v7, 12, v2
  v_lshl_or_b32 v7, v9, 11, v7
  v_lshl_or_b32 v7, v1, 4, v7
  v_lshlrev_b32 v15, 4, v1
  s_mov_b32 s14, 0x3c000000
  s_waitcnt lgkmcnt(0)
  s_barrier
  ds_read_b64 v[40:41], v11 offset:0
  s_cmp_eq_u32 s3, 0
  s_cbranch_scc0 K2_WV2
  ds_read_b128 v[32:35], v15 offset:0
  ds_read_b128 v[48:51], v12 offset:4096
  ds_read_b128 v[52:55], v12 offset:4112
  s_waitcnt lgkmcnt(2)
  v_add_f32 v32, v32, v33
  v_add_f32 v34, v34, v35
  v_add_f32 v14, v40, v41
  v_add_f32 v34, v34, v32
  v_mul_f32 v14, s14, v14
  s_nop 0
  v_add_f32_dpp v34, v34, v34 row_ror:8 row_mask:0xf bank_mask:0xf
  v_sub_f32 v16, v16, v14
  v_sub_f32 v17, v17, v14
  v_add_f32_dpp v34, v34, v34 row_ror:4 row_mask:0xf bank_mask:0xf
  v_sub_f32 v18, v18, v14
  v_sub_f32 v19, v19, v14
  v_add_f32_dpp v34, v34, v34 row_ror:2 row_mask:0xf bank_mask:0xf
  v_sub_f32 v20, v20, v14
  v_sub_f32 v21, v21, v14
  v_add_f32_dpp v34, v34, v34 row_ror:1 row_mask:0xf bank_mask:0xf
  v_sub_f32 v22, v22, v14
  v_sub_f32 v23, v23, v14
  v_mov_b32 v35, v34
  v_sub_f32 v24, v24, v14
  v_sub_f32 v25, v25, v14
  v_permlane16_swap_b32 v35, v34
  v_add_f32 v34, v34, v35
  v_mov_b32 v35, v34
  v_sub_f32 v26, v26, v14
  v_sub_f32 v27, v27, v14
  v_permlane32_swap_b32 v35, v34
  v_add_f32 v34, v34, v35
  v_sub_f32 v28, v28, v14
  v_sub_f32 v29, v29, v14
  v_sub_f32 v30, v30, v14
  v_sub_f32 v31, v31, v14
  s_waitcnt lgkmcnt(0)
  v_add_f32 v48, v48, v52
  v_add_f32 v49, v49, v53
  v_add_f32 v50, v50, v54
  v_add_f32 v51, v51, v55
  v_add_f32 v48, v48, v49
  v_add_f32 v50, v50, v51
  v_fma_f32 v48, v34, -s14, v48
  v_add_f32 v48, v48, v50
  v_mul_f32 v48, s14, v48
  s_mov_b32 s11, 327680
  s_nop 0
  v_subrev_f32_dpp v16, v48, v16 row_newbcast:0 row_mask:0xf bank_mask:0xf
  v_subrev_f32_dpp v17, v48, v17 row_newbcast:1 row_mask:0xf bank_mask:0xf
  v_subrev_f32_dpp v18, v48, v18 row_newbcast:2 row_mask:0xf bank_mask:0xf
  v_subrev_f32_dpp v19, v48, v19 row_newbcast:3 row_mask:0xf bank_mask:0xf
  v_subrev_f32_dpp v20, v48, v20 row_newbcast:4 row_mask:0xf bank_mask:0xf
  v_subrev_f32_dpp v21, v48, v21 row_newbcast:5 row_mask:0xf bank_mask:0xf
  v_subrev_f32_dpp v22, v48, v22 row_newbcast:6 row_mask:0xf bank_mask:0xf
  v_subrev_f32_dpp v23, v48, v23 row_newbcast:7 row_mask:0xf bank_mask:0xf
  v_subrev_f32_dpp v24, v48, v24 row_newbcast:8 row_mask:0xf bank_mask:0xf
  v_subrev_f32_dpp v25, v48, v25 row_newbcast:9 row_mask:0xf bank_mask:0xf
  v_subrev_f32_dpp v26, v48, v26 row_newbcast:10 row_mask:0xf bank_mask:0xf
  v_subrev_f32_dpp v27, v48, v27 row_newbcast:11 row_mask:0xf bank_mask:0xf
  v_subrev_f32_dpp v28, v48, v28 row_newbcast:12 row_mask:0xf bank_mask:0xf
  v_subrev_f32_dpp v29, v48, v29 row_newbcast:13 row_mask:0xf bank_mask:0xf
  v_subrev_f32_dpp v30, v48, v30 row_newbcast:14 row_mask:0xf bank_mask:0xf
  v_subrev_f32_dpp v31, v48, v31 row_newbcast:15 row_mask:0xf bank_mask:0xf
  s_branch K2_WST
K2_WV2:
  s_cmp_ge_u32 s10, 8192
  s_cbranch_scc1 K2_WV3
  ds_read_b128 v[32:35], v15 offset:0
  ds_read_b128 v[48:51], v12 offset:4096
  ds_read_b128 v[52:55], v12 offset:4112
  v_lshrrev_b32 v15, 4, v12
  v_and_b32 v15, 0xfe, v15
  buffer_load_ushort v42, v15, s[24:27], 0 offen
  s_waitcnt vmcnt(1)
  v_lshlrev_b32 v37, 16, v36
  v_and_b32 v36, 0xffff0000, v36
  v_add_f32 v38, v37, v36
  v_cmp_eq_u32 vcc, 0, v2
  s_nop 1
  v_cndmask_b32 v37, v37, 1.0, vcc
  v_cndmask_b32 v36, v36, 1.0, vcc
  s_waitcnt lgkmcnt(2)
  v_add_f32 v32, v32, v33
  v_add_f32 v34, v34, v35
  v_mul_f32 v37, v37, v32
  v_fmac_f32 v37, v36, v34
  s_nop 1
  v_add_f32_dpp v37, v37, v37 row_ror:8 row_mask:0xf bank_mask:0xf
  v_add_f32_dpp v38, v38, v38 row_ror:8 row_mask:0xf bank_mask:0xf
  s_nop 0
  v_add_f32_dpp v37, v37, v37 row_ror:4 row_mask:0xf bank_mask:0xf
  v_add_f32_dpp v38, v38, v38 row_ror:4 row_mask:0xf bank_mask:0xf
  s_nop 0
  v_add_f32_dpp v37, v37, v37 row_ror:2 row_mask:0xf bank_mask:0xf
  v_add_f32_dpp v38, v38, v38 row_ror:2 row_mask:0xf bank_mask:0xf
  s_nop 0
  v_add_f32_dpp v37, v37, v37 row_ror:1 row_mask:0xf bank_mask:0xf
  v_add_f32_dpp v38, v38, v38 row_ror:1 row_mask:0xf bank_mask:0xf
  v_mov_b32 v35, v37
  s_nop 1
  v_permlane16_swap_b32 v35, v37
  v_add_f32 v37, v37, v35
  v_mov_b32 v35, v37
  s_nop 1
  v_permlane32_swap_b32 v35, v37
  v_add_f32 v37, v37, v35
  v_mov_b32 v35, v38
  s_nop 1
  v_permlane16_swap_b32 v35, v38
  v_add_f32 v38, v38, v35
  v_mov_b32 v35, v38
  s_nop 1
  v_permlane32_swap_b32 v35, v38
  v_add_f32 v38, v38, v35
  s_waitcnt lgkmcnt(0)
  v_add_f32 v48, v48, v52
  v_add_f32 v49, v49, v53
  v_add_f32 v50, v50, v54
  v_add_f32 v51, v51, v55
  v_add_f32 v48, v48, v49
  v_add_f32 v50, v50, v51
  v_fma_f32 v48, v37, -s14, v48
  v_add_f32 v48, v48, v50
  v_cvt_pk_bf16_f32 v48, v48, v48
  v_mul_f32 v38, s14, v38
  v_lshrrev_b32 v15, 3, v3
  v_lshl_or_b32 v15, v9, 1, v15
  v_mul_u32_u24 v15, 1040, v15
  v_lshl_or_b32 v15, v4, 8, v15
  v_lshl_or_b32 v15, v2, 6, v15
  v_and_b32 v14, 7, v3
  v_lshl_or_b32 v15, v14, 1, v15
  s_mov_b32 s11, 393216
  v_mov_b32 v14, 0x3f80
  s_waitcnt vmcnt(0)
  buffer_store_short v48, v15, s[32:35], s11 offen offset:128
  v_cndmask_b32 v42, v42, v14, vcc
  buffer_store_short v42, v15, s[32:35], s11 offen
  v_mov_b32 v15, 0
  s_mov_b32 s11, 397312
  buffer_store_dword v38, v15, s[32:35], s11 offen
K2_WV3:
  s_waitcnt lgkmcnt(0)
  v_add_f32 v14, v40, v41
  v_mul_f32 v14, s14, v14
  s_mov_b32 s11, 360448
  v_sub_f32 v16, v16, v14
  v_sub_f32 v17, v17, v14
  v_sub_f32 v18, v18, v14
  v_sub_f32 v19, v19, v14
  v_sub_f32 v20, v20, v14
  v_sub_f32 v21, v21, v14
  v_sub_f32 v22, v22, v14
  v_sub_f32 v23, v23, v14
  v_sub_f32 v24, v24, v14
  v_sub_f32 v25, v25, v14
  v_sub_f32 v26, v26, v14
  v_sub_f32 v27, v27, v14
  v_sub_f32 v28, v28, v14
  v_sub_f32 v29, v29, v14
  v_sub_f32 v30, v30, v14
  v_sub_f32 v31, v31, v14
K2_WST:
  v_cvt_pk_bf16_f32 v64, v16, v17
  v_cvt_pk_bf16_f32 v65, v18, v19
  v_cvt_pk_bf16_f32 v66, v20, v21
  v_cvt_pk_bf16_f32 v67, v22, v23
  buffer_store_dwordx4 v[64:67], v7, s[32:35], s11 offen offset:0
  v_cvt_pk_bf16_f32 v68, v24, v25
  v_cvt_pk_bf16_f32 v69, v26, v27
  v_cvt_pk_bf16_f32 v70, v28, v29
  v_cvt_pk_bf16_f32 v71, v30, v31
  buffer_store_dwordx4 v[68:71], v7, s[32:35], s11 offen offset:1024
  s_endpgm
.globl k3_kernel
.p2align 8
.type k3_kernel,@function
k3_kernel:
  s_cmp_ge_u32 s2, 256
  s_cbranch_scc1 K3_END
  s_load_dwordx2 s[8:9], s[0:1], 88
  s_load_dwordx2 s[40:41], s[0:1], 24
  v_lshrrev_b32 v2, 6, v0
  v_and_b32 v1, 63, v0
  v_readfirstlane_b32 s3, v2
  v_lshlrev_b32 v1, 4, v1
  s_getreg_b32 s48, hwreg(HW_REG_XCC_ID, 0, 4)
  s_lshr_b32 s6, s2, 6
  s_and_b32 s5, s48, 7
  s_lshl_b32 s49, s6, 3
  s_add_u32 s49, s49, s5
  s_lshl_b32 s49, s49, 7
  s_lshl_b32 s5, s5, 2
  s_add_u32 s5, s5, s6
  s_cmp_lt_u32 s48, 8
  s_cselect_b32 s48, 1, 0x10001
  v_mov_b32 v3, s48
  v_mov_b32 v2, 133120
  s_mov_b32 s20, 0
  s_mov_b32 s10, 268435456
  s_mov_b32 s11, 0x00020000
  s_mov_b32 s14, 100352
  s_mov_b32 s15, 0x00020000
  s_mov_b32 s42, 25000
  s_mov_b32 s43, 0x00020000
  s_mov_b32 s4, 0
  s_waitcnt lgkmcnt(0)
  s_and_b32 s9, s9, 0xffff
  s_and_b32 s41, s41, 0xffff
  s_cmp_lg_u32 s3, 14
  s_cbranch_scc1 K3_DMA
  s_mov_b64 exec, 1
  buffer_atomic_add v3, v1, s[8:11], s49 offen sc0 sc1
  s_mov_b64 exec, -1
K3_DMA:
  s_mul_i32 s22, s5, 100352
  s_add_u32 s13, s22, 33554432
  s_mul_i32 s6, s3, 6144
  s_add_u32 s7, s6, s13
  s_mov_b32 m0, s6
  s_add_u32 s37, s7, 4096
  buffer_load_dwordx4 v1, s[8:11], s7 offen offset:0 lds
  buffer_load_dwordx4 v1, s[8:11], s7 offen offset:1024 lds
  buffer_load_dwordx4 v1, s[8:11], s7 offen offset:2048 lds
  buffer_load_dwordx4 v1, s[8:11], s7 offen offset:3072 lds
  s_add_u32 m0, s6, 4096
  s_nop 0
  buffer_load_dwordx4 v1, s[8:11], s37 offen offset:0 lds
  buffer_load_dwordx4 v1, s[8:11], s37 offen offset:1024 lds
  s_cmp_ge_u32 s3, 2
  s_cbranch_scc1 K3_ND
  s_lshl_b32 s6, s3, 10
  s_add_u32 s6, s6, 98304
  s_mov_b32 m0, s6
  s_add_u32 s7, s6, s13
  buffer_load_dwordx4 v1, s[8:11], s7 offen lds
K3_ND:
  s_cmp_lg_u32 s20, 0
  s_cbranch_scc1 K3_GO
  v_lshlrev_b32 v7, 4, v0
  v_add_u32 v7, 100352, v7
  v_mov_b32 v8, 0
  v_mov_b32 v9, 0
  v_mov_b32 v10, 0
  v_mov_b32 v11, 0
  ds_write_b128 v7, v[8:11]
  ds_write_b128 v7, v[8:11] offset:16384
  s_setreg_imm32_b32 hwreg(HW_REG_MODE, 4, 2), 3
  s_mov_b32 s16, 0
  s_mov_b32 s17, 0x10000
  s_mov_b32 s18, 1
  s_mov_b32 s46, 16
  s_mov_b32 s38, 0
  s_mov_b32 s19, 4194304
  s_mov_b32 s31, 0x1ffff
  s_mov_b32 s32, 0xaaaaaaaa
  s_mov_b32 s33, 0xaaaaaaaa
  s_mov_b32 s34, 0x3f80
  s_mov_b32 s35, 0x3f800000
  v_mov_b32 v0, 0
  v_and_b32 v6, 16, v1
  v_mov_b32 v4, 0x3f80
  v_lshlrev_b32 v4, v6, v4
  v_and_b32 v6, 32, v1
  v_cmp_eq_u32 vcc, 0, v6
  s_nop 1
  v_cndmask_b32 v5, v4, 0, vcc
  v_cndmask_b32 v4, 0, v4, vcc
  s_cmp_lg_u32 s3, 14
  s_cbranch_scc1 K3_T2
  s_mov_b32 s20, 7
  s_waitcnt vmcnt(6)
K3_T0:
  v_readfirstlane_b32 s4, v3
  s_and_b32 s4, s4, 0xffff
  s_cmp_lt_u32 s4, 8
  s_cbranch_scc1 K3_T1
  s_mov_b32 s4, 0
  s_sub_u32 s20, s20, 1
  s_cbranch_scc1 K3_T1
  s_add_u32 s6, s49, 128
  s_and_b32 s6, s6, 0x380
  s_andn2_b32 s49, s49, 0x380
  s_or_b32 s49, s49, s6
  v_mov_b32 v3, 0x10001
  s_mov_b64 exec, 1
  buffer_atomic_add v3, v1, s[8:11], s49 offen sc0 sc1
  s_mov_b64 exec, -1
  s_waitcnt vmcnt(0)
  s_branch K3_T0
K3_T1:
  s_or_b32 s4, s4, s49
  v_mov_b32 v3, s4
  ds_write_b32 v2, v3
K3_T2:
  s_waitcnt lgkmcnt(0)
  s_barrier
  ds_read_b32 v3, v2
  s_waitcnt lgkmcnt(0)
  v_readfirstlane_b32 s4, v3
  s_bfe_u32 s6, s4, 0x30007
  s_lshl_b32 s6, s6, 2
  s_bfe_u32 s7, s4, 0x2000a
  s_add_u32 s6, s6, s7
  s_and_b32 s4, s4, 7
  s_cmp_eq_u32 s6, s5
  s_cbranch_scc1 K3_GO
  s_mov_b32 s5, s6
  s_mov_b32 s20, 1
  s_waitcnt vmcnt(0)
  s_branch K3_DMA
K3_GO:
  s_mul_i32 s6, s4, 150528
  s_add_u32 s6, s6, 8388608
  s_cmp_ge_u32 s3, 12
  s_cbranch_scc1 K3_AUX
  s_mul_i32 s7, s3, 12544
  s_add_u32 s6, s6, s7
  s_add_u32 s7, s6, 4096
  s_add_u32 s50, s6, 6272
  s_add_u32 s51, s6, 10368
  buffer_load_dwordx4 v[36:39], v1, s[8:11], s7 offen offset:0
  buffer_load_dwordx4 v[44:47], v1, s[8:11], s7 offen offset:1024
  v_bfe_u32 v2, v1, 4, 1
  v_mul_u32_u24 v2, 6272, v2
  buffer_load_dword v30, v2, s[8:11], s7 offen offset:2048
  s_mul_i32 s26, s4, 3072
  s_lshl_b32 s27, s3, 8
  s_add_u32 s27, s27, s26
  v_lshrrev_b32 v2, 2, v1
  buffer_load_dword v3, v2, s[40:43], s27 offen
  buffer_load_dwordx4 v[52:55], v1, s[8:11], s51 offen offset:0
  buffer_load_dwordx4 v[60:63], v1, s[8:11], s51 offen offset:1024
  s_add_u32 s24, s8, s13
  s_addc_u32 s25, s9, 0
  s_add_u32 s12, s24, 3211264
  s_addc_u32 s13, s25, 0
  s_xor_b64 s[24:25], s[24:25], s[12:13]
  s_add_u32 s22, s22, 67108864
  s_lshl_b32 s27, s27, 2
  s_add_u32 s22, s22, s27
  s_lshl_b32 s26, s26, 1
  s_lshr_b32 s27, s3, 1
  s_lshl_b32 s27, s27, 10
  s_add_u32 s26, s26, s27
  s_and_b32 s27, s3, 1
  s_lshl_b32 s27, s27, 3
  s_add_u32 s26, s26, s27
  s_add_u32 s27, s26, 50176
  s_and_b32 s28, s3, 3
  s_mul_i32 s28, s28, 12288
  s_lshr_b32 s36, s3, 2
  s_lshl_b32 s29, s36, 11
  s_add_u32 s28, s28, s29
  s_mov_b32 m0, s28
  s_add_u32 s28, s28, 50176
  s_add_u32 s29, s28, 6144
  s_lshl_b32 s30, s3, 11
  s_add_u32 s30, s30, 100352
  s_mov_b64 vcc, s[32:33]
  s_waitcnt vmcnt(6)
  s_barrier
  s_cmp_lg_u32 s36, 0
  s_cbranch_scc1 L_k3_2
  s_setprio 2
L_k3_2:
  s_cmp_lg_u32 s36, 1
  s_cbranch_scc1 L_k3_3
  s_setprio 2
L_k3_3:
  s_cmp_lg_u32 s36, 2
  s_cbranch_scc1 L_k3_4
  s_setprio 2
L_k3_4:
  s_waitcnt vmcnt(5)
  v_lshlrev_b32_sdwa v32, 3, v36 dst_sel:DWORD dst_unused:UNUSED_PAD src0_sel:DWORD src1_sel:WORD_0
  v_lshlrev_b32_sdwa v33, 3, v36 dst_sel:DWORD dst_unused:UNUSED_PAD src0_sel:DWORD src1_sel:WORD_1
  v_lshlrev_b32_sdwa v34, 3, v37 dst_sel:DWORD dst_unused:UNUSED_PAD src0_sel:DWORD src1_sel:WORD_0
  v_lshlrev_b32_sdwa v35, 3, v37 dst_sel:DWORD dst_unused:UNUSED_PAD src0_sel:DWORD src1_sel:WORD_1
  v_lshlrev_b32_sdwa v36, 3, v38 dst_sel:DWORD dst_unused:UNUSED_PAD src0_sel:DWORD src1_sel:WORD_0
  v_lshlrev_b32_sdwa v37, 3, v38 dst_sel:DWORD dst_unused:UNUSED_PAD src0_sel:DWORD src1_sel:WORD_1
  v_lshlrev_b32_sdwa v38, 3, v39 dst_sel:DWORD dst_unused:UNUSED_PAD src0_sel:DWORD src1_sel:WORD_0
  v_lshlrev_b32_sdwa v39, 3, v39 dst_sel:DWORD dst_unused:UNUSED_PAD src0_sel:DWORD src1_sel:WORD_1
  buffer_load_dwordx4 v[68:71], v1, s[8:11], s6 offen offset:0
  ds_read_b64 v[16:17], v32
  ds_read_b64 v[18:19], v33
  ds_read_b64 v[20:21], v34
  ds_read_b64 v[22:23], v35
  ds_read_b64 v[24:25], v36
  ds_read_b64 v[26:27], v37
  s_waitcnt lgkmcnt(5)
  v_mfma_f32_4x4x4_16b_bf16 v[8:11], v[4:5], v[16:17], 0
  ds_read_b64 v[16:17], v38
  s_waitcnt lgkmcnt(5)
  v_mfma_f32_4x4x4_16b_bf16 v[8:11], v[4:5], v[18:19], v[8:11]
  ds_read_b64 v[18:19], v39
  s_waitcnt lgkmcnt(5)
  v_mfma_f32_4x4x4_16b_bf16 v[8:11], v[4:5], v[20:21], v[8:11]
  s_waitcnt vmcnt(5)
  v_lshlrev_b32_sdwa v40, 3, v44 dst_sel:DWORD dst_unused:UNUSED_PAD src0_sel:DWORD src1_sel:WORD_0
  v_lshlrev_b32_sdwa v41, 3, v44 dst_sel:DWORD dst_unused:UNUSED_PAD src0_sel:DWORD src1_sel:WORD_1
  v_lshlrev_b32_sdwa v42, 3, v45 dst_sel:DWORD dst_unused:UNUSED_PAD src0_sel:DWORD src1_sel:WORD_0
  v_lshlrev_b32_sdwa v43, 3, v45 dst_sel:DWORD dst_unused:UNUSED_PAD src0_sel:DWORD src1_sel:WORD_1
  v_lshlrev_b32_sdwa v44, 3, v46 dst_sel:DWORD dst_unused:UNUSED_PAD src0_sel:DWORD src1_sel:WORD_0
  v_lshlrev_b32_sdwa v45, 3, v46 dst_sel:DWORD dst_unused:UNUSED_PAD src0_sel:DWORD src1_sel:WORD_1
  v_lshlrev_b32_sdwa v46, 3, v47 dst_sel:DWORD dst_unused:UNUSED_PAD src0_sel:DWORD src1_sel:WORD_0
  v_lshlrev_b32_sdwa v47, 3, v47 dst_sel:DWORD dst_unused:UNUSED_PAD src0_sel:DWORD src1_sel:WORD_1
  buffer_load_dwordx4 v[76:79], v1, s[8:11], s6 offen offset:1024
  ds_read_b64 v[20:21], v40
  s_waitcnt lgkmcnt(5)
  v_mfma_f32_4x4x4_16b_bf16 v[8:11], v[4:5], v[22:23], v[8:11]
  ds_read_b64 v[22:23], v41
  s_waitcnt lgkmcnt(5)
  v_mfma_f32_4x4x4_16b_bf16 v[8:11], v[4:5], v[24:25], v[8:11]
  ds_read_b64 v[24:25], v42
  s_waitcnt lgkmcnt(5)
  v_mfma_f32_4x4x4_16b_bf16 v[8:11], v[4:5], v[26:27], v[8:11]
  ds_read_b64 v[26:27], v43
  s_waitcnt lgkmcnt(5)
  v_mfma_f32_4x4x4_16b_bf16 v[8:11], v[4:5], v[16:17], v[8:11]
  ds_read_b64 v[16:17], v44
  s_waitcnt lgkmcnt(5)
  v_mfma_f32_4x4x4_16b_bf16 v[8:11], v[4:5], v[18:19], v[8:11]
  ds_read_b64 v[18:19], v45
  s_waitcnt lgkmcnt(5)
  v_mfma_f32_4x4x4_16b_bf16 v[8:11], v[4:5], v[20:21], v[8:11]
  ds_read_b64 v[20:21], v46
  s_waitcnt lgkmcnt(5)
  v_mfma_f32_4x4x4_16b_bf16 v[8:11], v[4:5], v[22:23], v[8:11]
  ds_read_b64 v[22:23], v47
  s_waitcnt lgkmcnt(5)
  v_mfma_f32_4x4x4_16b_bf16 v[8:11], v[4:5], v[24:25], v[8:11]
  s_waitcnt vmcnt(3)
  v_lshlrev_b32_sdwa v48, 3, v52 dst_sel:DWORD dst_unused:UNUSED_PAD src0_sel:DWORD src1_sel:WORD_0
  v_lshlrev_b32_sdwa v49, 3, v52 dst_sel:DWORD dst_unused:UNUSED_PAD src0_sel:DWORD src1_sel:WORD_1
  v_lshlrev_b32_sdwa v50, 3, v53 dst_sel:DWORD dst_unused:UNUSED_PAD src0_sel:DWORD src1_sel:WORD_0
  v_lshlrev_b32_sdwa v51, 3, v53 dst_sel:DWORD dst_unused:UNUSED_PAD src0_sel:DWORD src1_sel:WORD_1
  v_lshlrev_b32_sdwa v52, 3, v54 dst_sel:DWORD dst_unused:UNUSED_PAD src0_sel:DWORD src1_sel:WORD_0
  v_lshlrev_b32_sdwa v53, 3, v54 dst_sel:DWORD dst_unused:UNUSED_PAD src0_sel:DWORD src1_sel:WORD_1
  v_lshlrev_b32_sdwa v54, 3, v55 dst_sel:DWORD dst_unused:UNUSED_PAD src0_sel:DWORD src1_sel:WORD_0
  v_lshlrev_b32_sdwa v55, 3, v55 dst_sel:DWORD dst_unused:UNUSED_PAD src0_sel:DWORD src1_sel:WORD_1
  buffer_load_dwordx4 v[84:87], v1, s[8:11], s6 offen offset:2048
  ds_read_b64 v[24:25], v48
  s_waitcnt lgkmcnt(5)
  v_mfma_f32_4x4x4_16b_bf16 v[8:11], v[4:5], v[26:27], v[8:11]
  ds_read_b64 v[26:27], v49
  s_waitcnt lgkmcnt(5)
  v_mfma_f32_4x4x4_16b_bf16 v[8:11], v[4:5], v[16:17], v[8:11]
  ds_read_b64 v[16:17], v50
  s_waitcnt lgkmcnt(5)
  v_mfma_f32_4x4x4_16b_bf16 v[8:11], v[4:5], v[18:19], v[8:11]
  ds_read_b64 v[18:19], v51
  s_waitcnt lgkmcnt(5)
  v_mfma_f32_4x4x4_16b_bf16 v[8:11], v[4:5], v[20:21], v[8:11]
  ds_read_b64 v[20:21], v52
  s_waitcnt lgkmcnt(5)
  v_mfma_f32_4x4x4_16b_bf16 v[8:11], v[4:5], v[22:23], v[8:11]
  ds_read_b64 v[22:23], v53
  s_waitcnt lgkmcnt(5)
  v_mfma_f32_4x4x4_16b_bf16 v[12:15], v[4:5], v[24:25], 0
  ds_read_b64 v[24:25], v54
  s_waitcnt lgkmcnt(5)
  v_mfma_f32_4x4x4_16b_bf16 v[12:15], v[4:5], v[26:27], v[12:15]
  ds_read_b64 v[26:27], v55
  s_waitcnt lgkmcnt(5)
  v_mfma_f32_4x4x4_16b_bf16 v[12:15], v[4:5], v[16:17], v[12:15]
  s_waitcnt vmcnt(3)
  v_lshlrev_b32_sdwa v56, 3, v60 dst_sel:DWORD dst_unused:UNUSED_PAD src0_sel:DWORD src1_sel:WORD_0
  v_lshlrev_b32_sdwa v57, 3, v60 dst_sel:DWORD dst_unused:UNUSED_PAD src0_sel:DWORD src1_sel:WORD_1
  v_lshlrev_b32_sdwa v58, 3, v61 dst_sel:DWORD dst_unused:UNUSED_PAD src0_sel:DWORD src1_sel:WORD_0
  v_lshlrev_b32_sdwa v59, 3, v61 dst_sel:DWORD dst_unused:UNUSED_PAD src0_sel:DWORD src1_sel:WORD_1
  v_lshlrev_b32_sdwa v60, 3, v62 dst_sel:DWORD dst_unused:UNUSED_PAD src0_sel:DWORD src1_sel:WORD_0
  v_lshlrev_b32_sdwa v61, 3, v62 dst_sel:DWORD dst_unused:UNUSED_PAD src0_sel:DWORD src1_sel:WORD_1
  v_lshlrev_b32_sdwa v62, 3, v63 dst_sel:DWORD dst_unused:UNUSED_PAD src0_sel:DWORD src1_sel:WORD_0
  v_lshlrev_b32_sdwa v63, 3, v63 dst_sel:DWORD dst_unused:UNUSED_PAD src0_sel:DWORD src1_sel:WORD_1
  buffer_load_dwordx4 v[92:95], v1, s[8:11], s6 offen offset:3072
  ds_read_b64 v[16:17], v56
  s_waitcnt lgkmcnt(5)
  v_mfma_f32_4x4x4_16b_bf16 v[12:15], v[4:5], v[18:19], v[12:15]
  ds_read_b64 v[18:19], v57
  s_waitcnt lgkmcnt(5)
  v_mfma_f32_4x4x4_16b_bf16 v[12:15], v[4:5], v[20:21], v[12:15]
  ds_read_b64 v[20:21], v58
  s_waitcnt lgkmcnt(5)
  v_mfma_f32_4x4x4_16b_bf16 v[12:15], v[4:5], v[22:23], v[12:15]
  ds_read_b64 v[22:23], v59
  s_waitcnt lgkmcnt(5)
  v_mfma_f32_4x4x4_16b_bf16 v[12:15], v[4:5], v[24:25], v[12:15]
  ds_read_b64 v[24:25], v60
  s_waitcnt lgkmcnt(5)
  v_mfma_f32_4x4x4_16b_bf16 v[12:15], v[4:5], v[26:27], v[12:15]
  ds_read_b64 v[26:27], v61
  s_waitcnt lgkmcnt(5)
  v_mfma_f32_4x4x4_16b_bf16 v[12:15], v[4:5], v[16:17], v[12:15]
  ds_read_b64 v[16:17], v62
  s_waitcnt lgkmcnt(5)
  v_mfma_f32_4x4x4_16b_bf16 v[12:15], v[4:5], v[18:19], v[12:15]
  ds_read_b64 v[18:19], v63
  s_waitcnt lgkmcnt(5)
  v_mfma_f32_4x4x4_16b_bf16 v[12:15], v[4:5], v[20:21], v[12:15]
  s_waitcnt vmcnt(3)
  v_lshlrev_b32_sdwa v64, 3, v68 dst_sel:DWORD dst_unused:UNUSED_PAD src0_sel:DWORD src1_sel:WORD_0
  v_lshlrev_b32_sdwa v65, 3, v68 dst_sel:DWORD dst_unused:UNUSED_PAD src0_sel:DWORD src1_sel:WORD_1
  v_lshlrev_b32_sdwa v66, 3, v69 dst_sel:DWORD dst_unused:UNUSED_PAD src0_sel:DWORD src1_sel:WORD_0
  v_lshlrev_b32_sdwa v67, 3, v69 dst_sel:DWORD dst_unused:UNUSED_PAD src0_sel:DWORD src1_sel:WORD_1
  v_lshlrev_b32_sdwa v68, 3, v70 dst_sel:DWORD dst_unused:UNUSED_PAD src0_sel:DWORD src1_sel:WORD_0
  v_lshlrev_b32_sdwa v69, 3, v70 dst_sel:DWORD dst_unused:UNUSED_PAD src0_sel:DWORD src1_sel:WORD_1
  v_lshlrev_b32_sdwa v70, 3, v71 dst_sel:DWORD dst_unused:UNUSED_PAD src0_sel:DWORD src1_sel:WORD_0
  v_lshlrev_b32_sdwa v71, 3, v71 dst_sel:DWORD dst_unused:UNUSED_PAD src0_sel:DWORD src1_sel:WORD_1
  buffer_load_dwordx4 v[100:103], v1, s[8:11], s50 offen offset:0
  ds_read_b64 v[20:21], v64
  s_waitcnt lgkmcnt(5)
  v_mfma_f32_4x4x4_16b_bf16 v[12:15], v[4:5], v[22:23], v[12:15]
  ds_read_b64 v[22:23], v65
  s_waitcnt lgkmcnt(5)
  v_mfma_f32_4x4x4_16b_bf16 v[12:15], v[4:5], v[24:25], v[12:15]
  ds_read_b64 v[24:25], v66
  v_cmp_ne_u32 vcc, 0, v30
  s_mov_b32 s21, vcc_lo
  v_lshlrev_b32 v2, 16, v3
  v_and_b32 v3, 0xffff0000, v3
  v_mov_b32 v30, 125440
L_k3_5:
  ds_read_b64 v[28:29], v30
  s_waitcnt lgkmcnt(0)
  v_readfirstlane_b32 s20, v28
  v_readfirstlane_b32 s37, v29
  s_mul_i32 s47, s20, s37
  s_cmp_lg_u32 s47, 0
  s_cbranch_scc1 L_k3_6
  s_sleep 1
  s_sub_u32 s19, s19, 1
  s_cbranch_scc0 L_k3_5
  s_mov_b32 s19, 0
L_k3_6:
  s_and_b32 s37, s37, 2
  s_or_b32 s21, s21, s37
  s_mov_b64 vcc, s[32:33]
  s_waitcnt lgkmcnt(5)
  v_mfma_f32_4x4x4_16b_bf16 v[12:15], v[4:5], v[26:27], v[12:15]
  ds_read_b64 v[26:27], v67
  s_waitcnt lgkmcnt(5)
  v_mfma_f32_4x4x4_16b_bf16 v[12:15], v[4:5], v[16:17], v[12:15]
  ds_read_b64 v[16:17], v68
  s_waitcnt lgkmcnt(5)
  v_mfma_f32_4x4x4_16b_bf16 v[12:15], v[4:5], v[18:19], v[12:15]
  ds_read_b64 v[18:19], v69
  s_waitcnt lgkmcnt(5)
  v_mfma_f32_4x4x4_16b_bf16 v[8:11], v[4:5], v[20:21], v[8:11]
  ds_read_b64 v[20:21], v70
  s_waitcnt lgkmcnt(5)
  v_mfma_f32_4x4x4_16b_bf16 v[8:11], v[4:5], v[22:23], v[8:11]
  ds_read_b64 v[22:23], v71
  s_waitcnt lgkmcnt(5)
  v_mfma_f32_4x4x4_16b_bf16 v[8:11], v[4:5], v[24:25], v[8:11]
  s_waitcnt vmcnt(3)
  v_lshlrev_b32_sdwa v72, 3, v76 dst_sel:DWORD dst_unused:UNUSED_PAD src0_sel:DWORD src1_sel:WORD_0
  v_lshlrev_b32_sdwa v73, 3, v76 dst_sel:DWORD dst_unused:UNUSED_PAD src0_sel:DWORD src1_sel:WORD_1
  v_lshlrev_b32_sdwa v74, 3, v77 dst_sel:DWORD dst_unused:UNUSED_PAD src0_sel:DWORD src1_sel:WORD_0
  v_lshlrev_b32_sdwa v75, 3, v77 dst_sel:DWORD dst_unused:UNUSED_PAD src0_sel:DWORD src1_sel:WORD_1
  v_lshlrev_b32_sdwa v76, 3, v78 dst_sel:DWORD dst_unused:UNUSED_PAD src0_sel:DWORD src1_sel:WORD_0
  v_lshlrev_b32_sdwa v77, 3, v78 dst_sel:DWORD dst_unused:UNUSED_PAD src0_sel:DWORD src1_sel:WORD_1
  v_lshlrev_b32_sdwa v78, 3, v79 dst_sel:DWORD dst_unused:UNUSED_PAD src0_sel:DWORD src1_sel:WORD_0
  v_lshlrev_b32_sdwa v79, 3, v79 dst_sel:DWORD dst_unused:UNUSED_PAD src0_sel:DWORD src1_sel:WORD_1
  buffer_load_dwordx4 v[108:111], v1, s[8:11], s50 offen offset:1024
  ds_read_b64 v[24:25], v72
  s_waitcnt lgkmcnt(5)
  v_mfma_f32_4x4x4_16b_bf16 v[8:11], v[4:5], v[26:27], v[8:11]
  ds_read_b64 v[26:27], v73
  s_waitcnt lgkmcnt(5)
  v_mfma_f32_4x4x4_16b_bf16 v[8:11], v[4:5], v[16:17], v[8:11]
  ds_read_b64 v[16:17], v74
  s_waitcnt lgkmcnt(5)
  v_mfma_f32_4x4x4_16b_bf16 v[8:11], v[4:5], v[18:19], v[8:11]
  ds_read_b64 v[18:19], v75
  s_waitcnt lgkmcnt(5)
  v_mfma_f32_4x4x4_16b_bf16 v[8:11], v[4:5], v[20:21], v[8:11]
  ds_read_b64 v[20:21], v76
  s_waitcnt lgkmcnt(5)
  v_mfma_f32_4x4x4_16b_bf16 v[8:11], v[4:5], v[22:23], v[8:11]
  ds_read_b64 v[22:23], v77
  s_waitcnt lgkmcnt(5)
  v_mfma_f32_4x4x4_16b_bf16 v[8:11], v[4:5], v[24:25], v[8:11]
  ds_read_b64 v[24:25], v78
  s_waitcnt lgkmcnt(5)
  v_mfma_f32_4x4x4_16b_bf16 v[8:11], v[4:5], v[26:27], v[8:11]
  ds_read_b64 v[26:27], v79
  s_waitcnt lgkmcnt(5)
  v_mfma_f32_4x4x4_16b_bf16 v[8:11], v[4:5], v[16:17], v[8:11]
  s_waitcnt vmcnt(3)
  v_lshlrev_b32_sdwa v80, 3, v84 dst_sel:DWORD dst_unused:UNUSED_PAD src0_sel:DWORD src1_sel:WORD_0
  v_lshlrev_b32_sdwa v81, 3, v84 dst_sel:DWORD dst_unused:UNUSED_PAD src0_sel:DWORD src1_sel:WORD_1
  v_lshlrev_b32_sdwa v82, 3, v85 dst_sel:DWORD dst_unused:UNUSED_PAD src0_sel:DWORD src1_sel:WORD_0
  v_lshlrev_b32_sdwa v83, 3, v85 dst_sel:DWORD dst_unused:UNUSED_PAD src0_sel:DWORD src1_sel:WORD_1
  v_lshlrev_b32_sdwa v84, 3, v86 dst_sel:DWORD dst_unused:UNUSED_PAD src0_sel:DWORD src1_sel:WORD_0
  v_lshlrev_b32_sdwa v85, 3, v86 dst_sel:DWORD dst_unused:UNUSED_PAD src0_sel:DWORD src1_sel:WORD_1
  v_lshlrev_b32_sdwa v86, 3, v87 dst_sel:DWORD dst_unused:UNUSED_PAD src0_sel:DWORD src1_sel:WORD_0
  v_lshlrev_b32_sdwa v87, 3, v87 dst_sel:DWORD dst_unused:UNUSED_PAD src0_sel:DWORD src1_sel:WORD_1
  buffer_load_dwordx4 v[116:119], v1, s[8:11], s50 offen offset:2048
  ds_read_b64 v[16:17], v80
  s_waitcnt lgkmcnt(5)
  v_mfma_f32_4x4x4_16b_bf16 v[8:11], v[4:5], v[18:19], v[8:11]
  ds_read_b64 v[18:19], v81
  s_waitcnt lgkmcnt(5)
  v_mfma_f32_4x4x4_16b_bf16 v[8:11], v[4:5], v[20:21], v[8:11]
  ds_read_b64 v[20:21], v82
  s_waitcnt lgkmcnt(5)
  v_mfma_f32_4x4x4_16b_bf16 v[8:11], v[4:5], v[22:23], v[8:11]
  ds_read_b64 v[22:23], v83
  s_waitcnt lgkmcnt(5)
  v_mfma_f32_4x4x4_16b_bf16 v[8:11], v[4:5], v[24:25], v[8:11]
  ds_read_b64 v[24:25], v84
  s_waitcnt lgkmcnt(5)
  v_mfma_f32_4x4x4_16b_bf16 v[8:11], v[4:5], v[26:27], v[8:11]
  ds_read_b64 v[26:27], v85
  s_waitcnt lgkmcnt(5)
  v_mfma_f32_4x4x4_16b_bf16 v[8:11], v[4:5], v[16:17], v[8:11]
  ds_read_b64 v[16:17], v86
  s_waitcnt lgkmcnt(5)
  v_mfma_f32_4x4x4_16b_bf16 v[8:11], v[4:5], v[18:19], v[8:11]
  ds_read_b64 v[18:19], v87
  s_waitcnt lgkmcnt(5)
  v_mfma_f32_4x4x4_16b_bf16 v[8:11], v[4:5], v[20:21], v[8:11]
  s_waitcnt vmcnt(3)
  v_lshlrev_b32_sdwa v88, 3, v92 dst_sel:DWORD dst_unused:UNUSED_PAD src0_sel:DWORD src1_sel:WORD_0
  v_lshlrev_b32_sdwa v89, 3, v92 dst_sel:DWORD dst_unused:UNUSED_PAD src0_sel:DWORD src1_sel:WORD_1
  v_lshlrev_b32_sdwa v90, 3, v93 dst_sel:DWORD dst_unused:UNUSED_PAD src0_sel:DWORD src1_sel:WORD_0
  v_lshlrev_b32_sdwa v91, 3, v93 dst_sel:DWORD dst_unused:UNUSED_PAD src0_sel:DWORD src1_sel:WORD_1
  v_lshlrev_b32_sdwa v92, 3, v94 dst_sel:DWORD dst_unused:UNUSED_PAD src0_sel:DWORD src1_sel:WORD_0
  v_lshlrev_b32_sdwa v93, 3, v94 dst_sel:DWORD dst_unused:UNUSED_PAD src0_sel:DWORD src1_sel:WORD_1
  v_lshlrev_b32_sdwa v94, 3, v95 dst_sel:DWORD dst_unused:UNUSED_PAD src0_sel:DWORD src1_sel:WORD_0
  v_lshlrev_b32_sdwa v95, 3, v95 dst_sel:DWORD dst_unused:UNUSED_PAD src0_sel:DWORD src1_sel:WORD_1
  buffer_load_dwordx4 v[124:127], v1, s[8:11], s50 offen offset:3072
  ds_read_b64 v[20:21], v88
  s_waitcnt lgkmcnt(5)
  v_mfma_f32_4x4x4_16b_bf16 v[8:11], v[4:5], v[22:23], v[8:11]
  ds_read_b64 v[22:23], v89
  s_waitcnt lgkmcnt(5)
  v_mfma_f32_4x4x4_16b_bf16 v[8:11], v[4:5], v[24:25], v[8:11]
  ds_read_b64 v[24:25], v90
  s_waitcnt lgkmcnt(5)
  v_mfma_f32_4x4x4_16b_bf16 v[8:11], v[4:5], v[26:27], v[8:11]
  ds_read_b64 v[26:27], v91
  s_cmp_eq_u32 s21, 0
  s_cbranch_scc1 L_k3_7
  v_mov_b32 v28, 125440
  ds_read_b32 v28, v28 offset:8
L_k3_7:
  s_waitcnt lgkmcnt(5)
  v_mfma_f32_4x4x4_16b_bf16 v[8:11], v[4:5], v[16:17], v[8:11]
  ds_read_b64 v[16:17], v92
  s_waitcnt lgkmcnt(5)
  v_mfma_f32_4x4x4_16b_bf16 v[8:11], v[4:5], v[18:19], v[8:11]
  ds_read_b64 v[18:19], v93
  s_waitcnt lgkmcnt(5)
  v_mfma_f32_4x4x4_16b_bf16 v[8:11], v[4:5], v[20:21], v[8:11]
  ds_read_b64 v[20:21], v94
  s_waitcnt lgkmcnt(5)
  v_mfma_f32_4x4x4_16b_bf16 v[8:11], v[4:5], v[22:23], v[8:11]
  ds_read_b64 v[22:23], v95
  s_waitcnt lgkmcnt(5)
  v_mfma_f32_4x4x4_16b_bf16 v[8:11], v[4:5], v[24:25], v[8:11]
  s_waitcnt vmcnt(3)
  v_lshlrev_b32_sdwa v96, 3, v100 dst_sel:DWORD dst_unused:UNUSED_PAD src0_sel:DWORD src1_sel:WORD_0
  v_lshlrev_b32_sdwa v97, 3, v100 dst_sel:DWORD dst_unused:UNUSED_PAD src0_sel:DWORD src1_sel:WORD_1
  v_lshlrev_b32_sdwa v98, 3, v101 dst_sel:DWORD dst_unused:UNUSED_PAD src0_sel:DWORD src1_sel:WORD_0
  v_lshlrev_b32_sdwa v99, 3, v101 dst_sel:DWORD dst_unused:UNUSED_PAD src0_sel:DWORD src1_sel:WORD_1
  v_lshlrev_b32_sdwa v100, 3, v102 dst_sel:DWORD dst_unused:UNUSED_PAD src0_sel:DWORD src1_sel:WORD_0
  v_lshlrev_b32_sdwa v101, 3, v102 dst_sel:DWORD dst_unused:UNUSED_PAD src0_sel:DWORD src1_sel:WORD_1
  v_lshlrev_b32_sdwa v102, 3, v103 dst_sel:DWORD dst_unused:UNUSED_PAD src0_sel:DWORD src1_sel:WORD_0
  v_lshlrev_b32_sdwa v103, 3, v103 dst_sel:DWORD dst_unused:UNUSED_PAD src0_sel:DWORD src1_sel:WORD_1
  ds_read_b64 v[24:25], v96
  s_waitcnt lgkmcnt(5)
  v_mfma_f32_4x4x4_16b_bf16 v[8:11], v[4:5], v[26:27], v[8:11]
  ds_read_b64 v[26:27], v97
  s_cmp_eq_u32 s21, 0
  s_cbranch_scc1 L_k3_8
  v_readfirstlane_b32 s37, v28
  s_cmp_ge_u32 s37, s18
  s_cbranch_scc0 L_k3_9
L_k3_10:
  v_add_u32 v28, s30, v1
  ds_read_b128 v[28:31], v28
L_k3_8:
  s_waitcnt lgkmcnt(5)
  v_mfma_f32_4x4x4_16b_bf16 v[8:11], v[4:5], v[16:17], v[8:11]
  ds_read_b64 v[16:17], v98
  s_waitcnt lgkmcnt(5)
  v_mfma_f32_4x4x4_16b_bf16 v[8:11], v[4:5], v[18:19], v[8:11]
  ds_read_b64 v[18:19], v99
  s_waitcnt lgkmcnt(5)
  v_mfma_f32_4x4x4_16b_bf16 v[8:11], v[4:5], v[20:21], v[8:11]
  ds_read_b64 v[20:21], v100
  s_waitcnt lgkmcnt(5)
  v_mfma_f32_4x4x4_16b_bf16 v[8:11], v[4:5], v[22:23], v[8:11]
  ds_read_b64 v[22:23], v101
  s_waitcnt lgkmcnt(5)
  v_mfma_f32_4x4x4_16b_bf16 v[12:15], v[4:5], v[24:25], v[12:15]
  ds_read_b64 v[24:25], v102
  s_waitcnt lgkmcnt(5)
  v_mfma_f32_4x4x4_16b_bf16 v[12:15], v[4:5], v[26:27], v[12:15]
  ds_read_b64 v[26:27], v103
  s_cmp_eq_u32 s21, 0
  s_cbranch_scc1 L_k3_11
  v_add_f32 v8, v8, v28
  v_add_f32 v9, v9, v29
  v_add_f32 v10, v10, v30
  v_add_f32 v11, v11, v31
  v_add_u32 v28, s30, v1
  ds_read_b128 v[28:31], v28 offset:1024
L_k3_11:
  s_waitcnt lgkmcnt(5)
  v_mfma_f32_4x4x4_16b_bf16 v[12:15], v[4:5], v[16:17], v[12:15]
  s_waitcnt vmcnt(2)
  v_lshlrev_b32_sdwa v104, 3, v108 dst_sel:DWORD dst_unused:UNUSED_PAD src0_sel:DWORD src1_sel:WORD_0
  v_lshlrev_b32_sdwa v105, 3, v108 dst_sel:DWORD dst_unused:UNUSED_PAD src0_sel:DWORD src1_sel:WORD_1
  v_lshlrev_b32_sdwa v106, 3, v109 dst_sel:DWORD dst_unused:UNUSED_PAD src0_sel:DWORD src1_sel:WORD_0
  v_lshlrev_b32_sdwa v107, 3, v109 dst_sel:DWORD dst_unused:UNUSED_PAD src0_sel:DWORD src1_sel:WORD_1
  v_lshlrev_b32_sdwa v108, 3, v110 dst_sel:DWORD dst_unused:UNUSED_PAD src0_sel:DWORD src1_sel:WORD_0
  v_lshlrev_b32_sdwa v109, 3, v110 dst_sel:DWORD dst_unused:UNUSED_PAD src0_sel:DWORD src1_sel:WORD_1
  v_lshlrev_b32_sdwa v110, 3, v111 dst_sel:DWORD dst_unused:UNUSED_PAD src0_sel:DWORD src1_sel:WORD_0
  v_lshlrev_b32_sdwa v111, 3, v111 dst_sel:DWORD dst_unused:UNUSED_PAD src0_sel:DWORD src1_sel:WORD_1
  ds_read_b64 v[16:17], v104
  v_mul_f32 v8, v8, v2
  v_mul_f32 v9, v9, v2
  v_mul_f32 v10, v10, v2
  v_mul_f32 v11, v11, v2
  v_cvt_pk_bf16_f32 v6, v8, v9
  v_cvt_pk_bf16_f32 v7, v10, v11
  v_mul_f32 v8, v8, v2
  v_mul_f32 v9, v9, v2
  v_mul_f32 v10, v10, v2
  v_mul_f32 v11, v11, v2
  v_add_u32 v8, s17, v8
  v_add_u32 v10, s17, v10
  v_bfi_b32 v8, s31, v0, v8
  v_bfi_b32 v10, s31, v0, v10
  v_cvt_pk_bf16_f32 v8, v8, v9
  v_cvt_pk_bf16_f32 v9, v10, v11
  s_nop 1
  v_mov_b32_dpp v10, v9 quad_perm:[0,0,1,1] row_mask:0xf bank_mask:0xf
  v_mov_b32_dpp v11, v9 quad_perm:[2,2,3,3] row_mask:0xf bank_mask:0xf
  s_nop 0
  v_cndmask_b32_dpp v10, v8, v10, vcc quad_perm:[0,0,1,1] row_mask:0xf bank_mask:0xf
  v_cndmask_b32_dpp v11, v8, v11, vcc quad_perm:[2,2,3,3] row_mask:0xf bank_mask:0xf
  s_waitcnt lgkmcnt(5)
  v_mfma_f32_4x4x4_16b_bf16 v[12:15], v[4:5], v[18:19], v[12:15]
  ds_read_b64 v[18:19], v105
  s_cmp_lg_u32 s36, 0
  s_cbranch_scc1 L_k3_13
  s_setprio 0
L_k3_13:
  s_cmp_lg_u32 s36, 1
  s_cbranch_scc1 L_k3_14
  s_setprio 0
L_k3_14:
  s_cmp_lg_u32 s36, 2
  s_cbranch_scc1 L_k3_15
  s_setprio 0
L_k3_15:
  s_cmp_eq_u32 s20, 1
  s_cbranch_scc0 L_k3_16
  buffer_store_dwordx2 v[10:11], v1, s[12:15], s26 offen
L_k3_17:
  s_waitcnt lgkmcnt(5)
  v_mfma_f32_4x4x4_16b_bf16 v[12:15], v[4:5], v[20:21], v[12:15]
  ds_read_b64 v[20:21], v106
  v_mul_f32 v8, v3, v3
  s_waitcnt lgkmcnt(5)
  v_mfma_f32_4x4x4_16b_bf16 v[12:15], v[4:5], v[22:23], v[12:15]
  ds_read_b64 v[22:23], v107
  s_waitcnt lgkmcnt(5)
  v_mfma_f32_4x4x4_16b_bf16 v[12:15], v[4:5], v[24:25], v[12:15]
  ds_read_b64 v[24:25], v108
  s_waitcnt lgkmcnt(5)
  v_mfma_f32_4x4x4_16b_bf16 v[12:15], v[4:5], v[26:27], v[12:15]
  ds_read_b64 v[26:27], v109
  v_mov_b32 v9, 1
  v_mov_b32 v10, 125440
  s_waitcnt lgkmcnt(5)
  v_mfma_f32_4x4x4_16b_bf16 v[12:15], v[4:5], v[16:17], v[12:15]
  ds_read_b64 v[16:17], v110
  s_waitcnt lgkmcnt(5)
  v_mfma_f32_4x4x4_16b_bf16 v[12:15], v[4:5], v[18:19], v[12:15]
  ds_read_b64 v[18:19], v111
  s_waitcnt lgkmcnt(5)
  v_mfma_f32_4x4x4_16b_bf16 v[12:15], v[4:5], v[20:21], v[12:15]
  s_waitcnt vmcnt(2)
  v_lshlrev_b32_sdwa v112, 3, v116 dst_sel:DWORD dst_unused:UNUSED_PAD src0_sel:DWORD src1_sel:WORD_0
  v_lshlrev_b32_sdwa v113, 3, v116 dst_sel:DWORD dst_unused:UNUSED_PAD src0_sel:DWORD src1_sel:WORD_1
  v_lshlrev_b32_sdwa v114, 3, v117 dst_sel:DWORD dst_unused:UNUSED_PAD src0_sel:DWORD src1_sel:WORD_0
  v_lshlrev_b32_sdwa v115, 3, v117 dst_sel:DWORD dst_unused:UNUSED_PAD src0_sel:DWORD src1_sel:WORD_1
  v_lshlrev_b32_sdwa v116, 3, v118 dst_sel:DWORD dst_unused:UNUSED_PAD src0_sel:DWORD src1_sel:WORD_0
  v_lshlrev_b32_sdwa v117, 3, v118 dst_sel:DWORD dst_unused:UNUSED_PAD src0_sel:DWORD src1_sel:WORD_1
  v_lshlrev_b32_sdwa v118, 3, v119 dst_sel:DWORD dst_unused:UNUSED_PAD src0_sel:DWORD src1_sel:WORD_0
  v_lshlrev_b32_sdwa v119, 3, v119 dst_sel:DWORD dst_unused:UNUSED_PAD src0_sel:DWORD src1_sel:WORD_1
  ds_read_b64 v[20:21], v112
  s_waitcnt lgkmcnt(5)
  v_mfma_f32_4x4x4_16b_bf16 v[12:15], v[4:5], v[22:23], v[12:15]
  ds_read_b64 v[22:23], v113
  s_waitcnt lgkmcnt(5)
  v_mfma_f32_4x4x4_16b_bf16 v[12:15], v[4:5], v[24:25], v[12:15]
  ds_read_b64 v[24:25], v114
  s_waitcnt lgkmcnt(5)
  v_mfma_f32_4x4x4_16b_bf16 v[12:15], v[4:5], v[26:27], v[12:15]
  ds_read_b64 v[26:27], v115
  s_waitcnt lgkmcnt(5)
  v_mfma_f32_4x4x4_16b_bf16 v[12:15], v[4:5], v[16:17], v[12:15]
  ds_read_b64 v[16:17], v116
  s_waitcnt lgkmcnt(5)
  v_mfma_f32_4x4x4_16b_bf16 v[12:15], v[4:5], v[18:19], v[12:15]
  ds_read_b64 v[18:19], v117
  s_waitcnt lgkmcnt(5)
  v_mfma_f32_4x4x4_16b_bf16 v[12:15], v[4:5], v[20:21], v[12:15]
  ds_read_b64 v[20:21], v118
  s_waitcnt lgkmcnt(5)
  v_mfma_f32_4x4x4_16b_bf16 v[12:15], v[4:5], v[22:23], v[12:15]
  ds_read_b64 v[22:23], v119
  s_waitcnt lgkmcnt(5)
  v_mfma_f32_4x4x4_16b_bf16 v[12:15], v[4:5], v[24:25], v[12:15]
  s_waitcnt vmcnt(1)
  v_lshlrev_b32_sdwa v120, 3, v124 dst_sel:DWORD dst_unused:UNUSED_PAD src0_sel:DWORD src1_sel:WORD_0
  v_lshlrev_b32_sdwa v121, 3, v124 dst_sel:DWORD dst_unused:UNUSED_PAD src0_sel:DWORD src1_sel:WORD_1
  v_lshlrev_b32_sdwa v122, 3, v125 dst_sel:DWORD dst_unused:UNUSED_PAD src0_sel:DWORD src1_sel:WORD_0
  v_lshlrev_b32_sdwa v123, 3, v125 dst_sel:DWORD dst_unused:UNUSED_PAD src0_sel:DWORD src1_sel:WORD_1
  v_lshlrev_b32_sdwa v124, 3, v126 dst_sel:DWORD dst_unused:UNUSED_PAD src0_sel:DWORD src1_sel:WORD_0
  v_lshlrev_b32_sdwa v125, 3, v126 dst_sel:DWORD dst_unused:UNUSED_PAD src0_sel:DWORD src1_sel:WORD_1
  v_lshlrev_b32_sdwa v126, 3, v127 dst_sel:DWORD dst_unused:UNUSED_PAD src0_sel:DWORD src1_sel:WORD_0
  v_lshlrev_b32_sdwa v127, 3, v127 dst_sel:DWORD dst_unused:UNUSED_PAD src0_sel:DWORD src1_sel:WORD_1
  ds_read_b64 v[24:25], v120
  s_waitcnt lgkmcnt(5)
  v_mfma_f32_4x4x4_16b_bf16 v[12:15], v[4:5], v[26:27], v[12:15]
  ds_read_b64 v[26:27], v121
  s_waitcnt lgkmcnt(5)
  v_mfma_f32_4x4x4_16b_bf16 v[12:15], v[4:5], v[16:17], v[12:15]
  ds_read_b64 v[16:17], v122
  s_waitcnt lgkmcnt(5)
  v_mfma_f32_4x4x4_16b_bf16 v[12:15], v[4:5], v[18:19], v[12:15]
  ds_read_b64 v[18:19], v123
  s_waitcnt lgkmcnt(5)
  v_mfma_f32_4x4x4_16b_bf16 v[12:15], v[4:5], v[20:21], v[12:15]
  ds_read_b64 v[20:21], v124
  s_waitcnt lgkmcnt(5)
  v_mfma_f32_4x4x4_16b_bf16 v[12:15], v[4:5], v[22:23], v[12:15]
  ds_read_b64 v[22:23], v125
  s_waitcnt lgkmcnt(5)
  v_mfma_f32_4x4x4_16b_bf16 v[12:15], v[4:5], v[24:25], v[12:15]
  ds_read_b64 v[24:25], v126
  s_waitcnt lgkmcnt(5)
  v_mfma_f32_4x4x4_16b_bf16 v[12:15], v[4:5], v[26:27], v[12:15]
  ds_read_b64 v[26:27], v127
  s_mov_b64 exec, 1
  ds_add_u32 v10, v9 offset:12
  s_mov_b64 exec, -1
  s_waitcnt lgkmcnt(6)
  v_mfma_f32_4x4x4_16b_bf16 v[12:15], v[4:5], v[16:17], v[12:15]
  s_waitcnt lgkmcnt(5)
  s_nop 0
  v_mfma_f32_4x4x4_16b_bf16 v[12:15], v[4:5], v[18:19], v[12:15]
  s_waitcnt lgkmcnt(4)
  s_nop 0
  v_mfma_f32_4x4x4_16b_bf16 v[12:15], v[4:5], v[20:21], v[12:15]
  s_waitcnt lgkmcnt(3)
  s_nop 0
  v_mfma_f32_4x4x4_16b_bf16 v[12:15], v[4:5], v[22:23], v[12:15]
  s_waitcnt lgkmcnt(2)
  s_nop 0
  v_mfma_f32_4x4x4_16b_bf16 v[12:15], v[4:5], v[24:25], v[12:15]
  s_waitcnt lgkmcnt(1)
  s_nop 0
  v_mfma_f32_4x4x4_16b_bf16 v[12:15], v[4:5], v[26:27], v[12:15]
  s_cmp_eq_u32 s36, 1
  s_cbranch_scc1 K3_TAIL1
  s_cmp_eq_u32 s36, 2
  s_cbranch_scc1 K3_TAIL2
  s_branch K3_TAIL0
K3_LOOP0:
  s_setprio 2
  ds_read_b64 v[16:17], v32
  ds_read_b64 v[18:19], v33
  ds_read_b64 v[20:21], v34
  ds_read_b64 v[22:23], v35
  ds_read_b64 v[24:25], v36
  ds_read_b64 v[26:27], v37
  s_waitcnt lgkmcnt(5)
  v_mfma_f32_4x4x4_16b_bf16 v[8:11], v[4:5], v[16:17], 0
  ds_read_b64 v[16:17], v38
  s_waitcnt lgkmcnt(5)
  v_mfma_f32_4x4x4_16b_bf16 v[8:11], v[4:5], v[18:19], v[8:11]
  ds_read_b64 v[18:19], v39
  s_waitcnt lgkmcnt(5)
  v_mfma_f32_4x4x4_16b_bf16 v[8:11], v[4:5], v[20:21], v[8:11]
  ds_read_b64 v[20:21], v40
  s_waitcnt lgkmcnt(5)
  v_mfma_f32_4x4x4_16b_bf16 v[8:11], v[4:5], v[22:23], v[8:11]
  ds_read_b64 v[22:23], v41
  s_waitcnt lgkmcnt(5)
  v_mfma_f32_4x4x4_16b_bf16 v[8:11], v[4:5], v[24:25], v[8:11]
  ds_read_b64 v[24:25], v42
  s_waitcnt lgkmcnt(5)
  v_mfma_f32_4x4x4_16b_bf16 v[8:11], v[4:5], v[26:27], v[8:11]
  ds_read_b64 v[26:27], v43
  s_waitcnt lgkmcnt(5)
  v_mfma_f32_4x4x4_16b_bf16 v[8:11], v[4:5], v[16:17], v[8:11]
  ds_read_b64 v[16:17], v44
  s_waitcnt lgkmcnt(5)
  v_mfma_f32_4x4x4_16b_bf16 v[8:11], v[4:5], v[18:19], v[8:11]
  ds_read_b64 v[18:19], v45
  s_waitcnt lgkmcnt(5)
  v_mfma_f32_4x4x4_16b_bf16 v[8:11], v[4:5], v[20:21], v[8:11]
  ds_read_b64 v[20:21], v46
  buffer_store_dwordx4 v[28:31], v1, s[8:11], s22 offen sc1
  s_add_u32 s22, s22, 3211264
  s_waitcnt lgkmcnt(5)
  v_mfma_f32_4x4x4_16b_bf16 v[8:11], v[4:5], v[22:23], v[8:11]
  ds_read_b64 v[22:23], v47
  s_waitcnt lgkmcnt(5)
  v_mfma_f32_4x4x4_16b_bf16 v[8:11], v[4:5], v[24:25], v[8:11]
  ds_read_b64 v[24:25], v48
  s_waitcnt lgkmcnt(5)
  v_mfma_f32_4x4x4_16b_bf16 v[8:11], v[4:5], v[26:27], v[8:11]
  ds_read_b64 v[26:27], v49
  s_waitcnt lgkmcnt(5)
  v_mfma_f32_4x4x4_16b_bf16 v[8:11], v[4:5], v[16:17], v[8:11]
  ds_read_b64 v[16:17], v50
  s_waitcnt lgkmcnt(5)
  v_mfma_f32_4x4x4_16b_bf16 v[8:11], v[4:5], v[18:19], v[8:11]
  ds_read_b64 v[18:19], v51
  s_waitcnt lgkmcnt(5)
  v_mfma_f32_4x4x4_16b_bf16 v[8:11], v[4:5], v[20:21], v[8:11]
  ds_read_b64 v[20:21], v52
  s_waitcnt lgkmcnt(5)
  v_mfma_f32_4x4x4_16b_bf16 v[8:11], v[4:5], v[22:23], v[8:11]
  ds_read_b64 v[22:23], v53
  s_waitcnt lgkmcnt(5)
  v_mfma_f32_4x4x4_16b_bf16 v[12:15], v[4:5], v[24:25], 0
  ds_read_b64 v[24:25], v54
  s_waitcnt lgkmcnt(5)
  v_mfma_f32_4x4x4_16b_bf16 v[12:15], v[4:5], v[26:27], v[12:15]
  ds_read_b64 v[26:27], v55
  s_waitcnt lgkmcnt(5)
  v_mfma_f32_4x4x4_16b_bf16 v[12:15], v[4:5], v[16:17], v[12:15]
  ds_read_b64 v[16:17], v56
  s_waitcnt lgkmcnt(5)
  v_mfma_f32_4x4x4_16b_bf16 v[12:15], v[4:5], v[18:19], v[12:15]
  ds_read_b64 v[18:19], v57
  v_mov_b32 v6, 125440
  ds_read_b32 v6, v6 offset:16
  s_waitcnt lgkmcnt(5)
  v_mfma_f32_4x4x4_16b_bf16 v[12:15], v[4:5], v[20:21], v[12:15]
  ds_read_b64 v[20:21], v58
  s_waitcnt lgkmcnt(5)
  v_mfma_f32_4x4x4_16b_bf16 v[12:15], v[4:5], v[22:23], v[12:15]
  ds_read_b64 v[22:23], v59
  s_waitcnt lgkmcnt(5)
  v_mfma_f32_4x4x4_16b_bf16 v[12:15], v[4:5], v[24:25], v[12:15]
  ds_read_b64 v[24:25], v60
  s_waitcnt lgkmcnt(5)
  v_mfma_f32_4x4x4_16b_bf16 v[12:15], v[4:5], v[26:27], v[12:15]
  ds_read_b64 v[26:27], v61
  s_waitcnt lgkmcnt(5)
  v_mfma_f32_4x4x4_16b_bf16 v[12:15], v[4:5], v[16:17], v[12:15]
  ds_read_b64 v[16:17], v62
  s_waitcnt lgkmcnt(5)
  v_mfma_f32_4x4x4_16b_bf16 v[12:15], v[4:5], v[18:19], v[12:15]
  ds_read_b64 v[18:19], v63
  v_readfirstlane_b32 s37, v6
  s_cmp_ge_u32 s37, s38
  s_cbranch_scc0 L_k3_18
L_k3_19:
  s_waitcnt lgkmcnt(5)
  v_mfma_f32_4x4x4_16b_bf16 v[12:15], v[4:5], v[20:21], v[12:15]
  ds_read_b64 v[20:21], v64
  s_waitcnt lgkmcnt(5)
  v_mfma_f32_4x4x4_16b_bf16 v[12:15], v[4:5], v[22:23], v[12:15]
  ds_read_b64 v[22:23], v65
  s_waitcnt lgkmcnt(5)
  v_mfma_f32_4x4x4_16b_bf16 v[12:15], v[4:5], v[24:25], v[12:15]
  ds_read_b64 v[24:25], v66
  s_waitcnt lgkmcnt(5)
  v_mfma_f32_4x4x4_16b_bf16 v[12:15], v[4:5], v[26:27], v[12:15]
  ds_read_b64 v[26:27], v67
  s_waitcnt lgkmcnt(5)
  v_mfma_f32_4x4x4_16b_bf16 v[12:15], v[4:5], v[16:17], v[12:15]
  ds_read_b64 v[16:17], v68
  s_waitcnt lgkmcnt(5)
  v_mfma_f32_4x4x4_16b_bf16 v[12:15], v[4:5], v[18:19], v[12:15]
  ds_read_b64 v[18:19], v69
  s_waitcnt lgkmcnt(5)
  v_mfma_f32_4x4x4_16b_bf16 v[8:11], v[4:5], v[20:21], v[8:11]
  ds_read_b64 v[20:21], v70
  s_waitcnt lgkmcnt(5)
  v_mfma_f32_4x4x4_16b_bf16 v[8:11], v[4:5], v[22:23], v[8:11]
  ds_read_b64 v[22:23], v71
  s_waitcnt lgkmcnt(5)
  v_mfma_f32_4x4x4_16b_bf16 v[8:11], v[4:5], v[24:25], v[8:11]
  ds_read_b64 v[24:25], v72
  s_waitcnt lgkmcnt(5)
  v_mfma_f32_4x4x4_16b_bf16 v[8:11], v[4:5], v[26:27], v[8:11]
  ds_read_b64 v[26:27], v73
  s_waitcnt lgkmcnt(5)
  v_mfma_f32_4x4x4_16b_bf16 v[8:11], v[4:5], v[16:17], v[8:11]
  ds_read_b64 v[16:17], v74
  s_waitcnt lgkmcnt(5)
  v_mfma_f32_4x4x4_16b_bf16 v[8:11], v[4:5], v[18:19], v[8:11]
  ds_read_b64 v[18:19], v75
  s_waitcnt lgkmcnt(5)
  v_mfma_f32_4x4x4_16b_bf16 v[8:11], v[4:5], v[20:21], v[8:11]
  ds_read_b64 v[20:21], v76
  s_waitcnt lgkmcnt(5)
  v_mfma_f32_4x4x4_16b_bf16 v[8:11], v[4:5], v[22:23], v[8:11]
  ds_read_b64 v[22:23], v77
  s_waitcnt lgkmcnt(5)
  v_mfma_f32_4x4x4_16b_bf16 v[8:11], v[4:5], v[24:25], v[8:11]
  ds_read_b64 v[24:25], v78
  s_waitcnt lgkmcnt(5)
  v_mfma_f32_4x4x4_16b_bf16 v[8:11], v[4:5], v[26:27], v[8:11]
  ds_read_b64 v[26:27], v79
  s_waitcnt lgkmcnt(5)
  v_mfma_f32_4x4x4_16b_bf16 v[8:11], v[4:5], v[16:17], v[8:11]
  ds_read_b64 v[16:17], v80
  s_waitcnt lgkmcnt(5)
  v_mfma_f32_4x4x4_16b_bf16 v[8:11], v[4:5], v[18:19], v[8:11]
  ds_read_b64 v[18:19], v81
  s_waitcnt lgkmcnt(5)
  v_mfma_f32_4x4x4_16b_bf16 v[8:11], v[4:5], v[20:21], v[8:11]
  ds_read_b64 v[20:21], v82
  s_waitcnt lgkmcnt(5)
  v_mfma_f32_4x4x4_16b_bf16 v[8:11], v[4:5], v[22:23], v[8:11]
  ds_read_b64 v[22:23], v83
  s_waitcnt lgkmcnt(5)
  v_mfma_f32_4x4x4_16b_bf16 v[8:11], v[4:5], v[24:25], v[8:11]
  ds_read_b64 v[24:25], v84
  s_waitcnt lgkmcnt(5)
  v_mfma_f32_4x4x4_16b_bf16 v[8:11], v[4:5], v[26:27], v[8:11]
  ds_read_b64 v[26:27], v85
  s_waitcnt lgkmcnt(5)
  v_mfma_f32_4x4x4_16b_bf16 v[8:11], v[4:5], v[16:17], v[8:11]
  ds_read_b64 v[16:17], v86
  s_waitcnt lgkmcnt(5)
  v_mfma_f32_4x4x4_16b_bf16 v[8:11], v[4:5], v[18:19], v[8:11]
  ds_read_b64 v[18:19], v87
  s_waitcnt lgkmcnt(5)
  v_mfma_f32_4x4x4_16b_bf16 v[8:11], v[4:5], v[20:21], v[8:11]
  ds_read_b64 v[20:21], v88
  s_waitcnt lgkmcnt(5)
  v_mfma_f32_4x4x4_16b_bf16 v[8:11], v[4:5], v[22:23], v[8:11]
  ds_read_b64 v[22:23], v89
  s_waitcnt lgkmcnt(5)
  v_mfma_f32_4x4x4_16b_bf16 v[8:11], v[4:5], v[24:25], v[8:11]
  ds_read_b64 v[24:25], v90
  s_waitcnt lgkmcnt(5)
  v_mfma_f32_4x4x4_16b_bf16 v[8:11], v[4:5], v[26:27], v[8:11]
  ds_read_b64 v[26:27], v91
  s_cmp_eq_u32 s21, 0
  s_cbranch_scc1 L_k3_20
  v_mov_b32 v28, 125440
  ds_read_b32 v28, v28 offset:8
L_k3_20:
  s_waitcnt lgkmcnt(5)
  v_mfma_f32_4x4x4_16b_bf16 v[8:11], v[4:5], v[16:17], v[8:11]
  ds_read_b64 v[16:17], v92
  s_waitcnt lgkmcnt(5)
  v_mfma_f32_4x4x4_16b_bf16 v[8:11], v[4:5], v[18:19], v[8:11]
  ds_read_b64 v[18:19], v93
  s_waitcnt lgkmcnt(5)
  v_mfma_f32_4x4x4_16b_bf16 v[8:11], v[4:5], v[20:21], v[8:11]
  ds_read_b64 v[20:21], v94
  s_waitcnt lgkmcnt(5)
  v_mfma_f32_4x4x4_16b_bf16 v[8:11], v[4:5], v[22:23], v[8:11]
  ds_read_b64 v[22:23], v95
  s_waitcnt lgkmcnt(5)
  v_mfma_f32_4x4x4_16b_bf16 v[8:11], v[4:5], v[24:25], v[8:11]
  ds_read_b64 v[24:25], v96
  s_waitcnt lgkmcnt(5)
  v_mfma_f32_4x4x4_16b_bf16 v[8:11], v[4:5], v[26:27], v[8:11]
  ds_read_b64 v[26:27], v97
  s_cmp_eq_u32 s21, 0
  s_cbranch_scc1 L_k3_21
  v_readfirstlane_b32 s37, v28
  s_cmp_ge_u32 s37, s18
  s_cbranch_scc0 L_k3_22
L_k3_23:
  v_add_u32 v28, s30, v1
  ds_read_b128 v[28:31], v28
L_k3_21:
  s_waitcnt lgkmcnt(5)
  v_mfma_f32_4x4x4_16b_bf16 v[8:11], v[4:5], v[16:17], v[8:11]
  ds_read_b64 v[16:17], v98
  s_waitcnt lgkmcnt(5)
  v_mfma_f32_4x4x4_16b_bf16 v[8:11], v[4:5], v[18:19], v[8:11]
  ds_read_b64 v[18:19], v99
  s_waitcnt lgkmcnt(5)
  v_mfma_f32_4x4x4_16b_bf16 v[8:11], v[4:5], v[20:21], v[8:11]
  ds_read_b64 v[20:21], v100
  s_waitcnt lgkmcnt(5)
  v_mfma_f32_4x4x4_16b_bf16 v[8:11], v[4:5], v[22:23], v[8:11]
  ds_read_b64 v[22:23], v101
  s_waitcnt lgkmcnt(5)
  v_mfma_f32_4x4x4_16b_bf16 v[12:15], v[4:5], v[24:25], v[12:15]
  ds_read_b64 v[24:25], v102
  s_waitcnt lgkmcnt(5)
  v_mfma_f32_4x4x4_16b_bf16 v[12:15], v[4:5], v[26:27], v[12:15]
  ds_read_b64 v[26:27], v103
  s_cmp_eq_u32 s21, 0
  s_cbranch_scc1 L_k3_24
  v_add_f32 v8, v8, v28
  v_add_f32 v9, v9, v29
  v_add_f32 v10, v10, v30
  v_add_f32 v11, v11, v31
  v_add_u32 v28, s30, v1
  ds_read_b128 v[28:31], v28 offset:1024
L_k3_24:
  s_waitcnt lgkmcnt(5)
  v_mfma_f32_4x4x4_16b_bf16 v[12:15], v[4:5], v[16:17], v[12:15]
  ds_read_b64 v[16:17], v104
  v_mul_f32 v8, v8, v2
  v_mul_f32 v9, v9, v2
  v_mul_f32 v10, v10, v2
  v_mul_f32 v11, v11, v2
  v_cvt_pk_bf16_f32 v6, v8, v9
  v_cvt_pk_bf16_f32 v7, v10, v11
  v_mul_f32 v8, v8, v2
  v_mul_f32 v9, v9, v2
  v_mul_f32 v10, v10, v2
  v_mul_f32 v11, v11, v2
  v_add_u32 v8, s17, v8
  v_add_u32 v10, s17, v10
  v_bfi_b32 v8, s31, v0, v8
  v_bfi_b32 v10, s31, v0, v10
  v_cvt_pk_bf16_f32 v8, v8, v9
  v_cvt_pk_bf16_f32 v9, v10, v11
  s_nop 1
  v_mov_b32_dpp v10, v9 quad_perm:[0,0,1,1] row_mask:0xf bank_mask:0xf
  v_mov_b32_dpp v11, v9 quad_perm:[2,2,3,3] row_mask:0xf bank_mask:0xf
  s_nop 0
  v_cndmask_b32_dpp v10, v8, v10, vcc quad_perm:[0,0,1,1] row_mask:0xf bank_mask:0xf
  v_cndmask_b32_dpp v11, v8, v11, vcc quad_perm:[2,2,3,3] row_mask:0xf bank_mask:0xf
  s_waitcnt lgkmcnt(5)
  v_mfma_f32_4x4x4_16b_bf16 v[12:15], v[4:5], v[18:19], v[12:15]
  ds_read_b64 v[18:19], v105
  s_setprio 0
  s_cmp_eq_u32 s20, 1
  s_cbranch_scc0 L_k3_25
  buffer_store_dwordx2 v[10:11], v1, s[12:15], s26 offen
L_k3_26:
  s_waitcnt lgkmcnt(5)
  v_mfma_f32_4x4x4_16b_bf16 v[12:15], v[4:5], v[20:21], v[12:15]
  ds_read_b64 v[20:21], v106
  v_mul_f32 v8, v3, v3
  s_waitcnt lgkmcnt(5)
  v_mfma_f32_4x4x4_16b_bf16 v[12:15], v[4:5], v[22:23], v[12:15]
  ds_read_b64 v[22:23], v107
  s_waitcnt lgkmcnt(5)
  v_mfma_f32_4x4x4_16b_bf16 v[12:15], v[4:5], v[24:25], v[12:15]
  ds_read_b64 v[24:25], v108
  s_waitcnt lgkmcnt(5)
  v_mfma_f32_4x4x4_16b_bf16 v[12:15], v[4:5], v[26:27], v[12:15]
  ds_read_b64 v[26:27], v109
  v_mov_b32 v9, 1
  v_mov_b32 v10, 125440
  s_waitcnt lgkmcnt(5)
  v_mfma_f32_4x4x4_16b_bf16 v[12:15], v[4:5], v[16:17], v[12:15]
  ds_read_b64 v[16:17], v110
  s_waitcnt lgkmcnt(5)
  v_mfma_f32_4x4x4_16b_bf16 v[12:15], v[4:5], v[18:19], v[12:15]
  ds_read_b64 v[18:19], v111
  s_waitcnt lgkmcnt(5)
  v_mfma_f32_4x4x4_16b_bf16 v[12:15], v[4:5], v[20:21], v[12:15]
  ds_read_b64 v[20:21], v112
  s_waitcnt lgkmcnt(5)
  v_mfma_f32_4x4x4_16b_bf16 v[12:15], v[4:5], v[22:23], v[12:15]
  ds_read_b64 v[22:23], v113
  s_waitcnt lgkmcnt(5)
  v_mfma_f32_4x4x4_16b_bf16 v[12:15], v[4:5], v[24:25], v[12:15]
  ds_read_b64 v[24:25], v114
  s_waitcnt lgkmcnt(5)
  v_mfma_f32_4x4x4_16b_bf16 v[12:15], v[4:5], v[26:27], v[12:15]
  ds_read_b64 v[26:27], v115
  s_waitcnt lgkmcnt(5)
  v_mfma_f32_4x4x4_16b_bf16 v[12:15], v[4:5], v[16:17], v[12:15]
  ds_read_b64 v[16:17], v116
  s_waitcnt lgkmcnt(5)
  v_mfma_f32_4x4x4_16b_bf16 v[12:15], v[4:5], v[18:19], v[12:15]
  ds_read_b64 v[18:19], v117
  s_waitcnt lgkmcnt(5)
  v_mfma_f32_4x4x4_16b_bf16 v[12:15], v[4:5], v[20:21], v[12:15]
  ds_read_b64 v[20:21], v118
  s_waitcnt lgkmcnt(5)
  v_mfma_f32_4x4x4_16b_bf16 v[12:15], v[4:5], v[22:23], v[12:15]
  ds_read_b64 v[22:23], v119
  s_waitcnt lgkmcnt(5)
  v_mfma_f32_4x4x4_16b_bf16 v[12:15], v[4:5], v[24:25], v[12:15]
  ds_read_b64 v[24:25], v120
  s_waitcnt lgkmcnt(5)
  v_mfma_f32_4x4x4_16b_bf16 v[12:15], v[4:5], v[26:27], v[12:15]
  ds_read_b64 v[26:27], v121
  s_waitcnt lgkmcnt(5)
  v_mfma_f32_4x4x4_16b_bf16 v[12:15], v[4:5], v[16:17], v[12:15]
  ds_read_b64 v[16:17], v122
  s_waitcnt lgkmcnt(5)
  v_mfma_f32_4x4x4_16b_bf16 v[12:15], v[4:5], v[18:19], v[12:15]
  ds_read_b64 v[18:19], v123
  s_waitcnt lgkmcnt(5)
  v_mfma_f32_4x4x4_16b_bf16 v[12:15], v[4:5], v[20:21], v[12:15]
  ds_read_b64 v[20:21], v124
  s_waitcnt lgkmcnt(5)
  v_mfma_f32_4x4x4_16b_bf16 v[12:15], v[4:5], v[22:23], v[12:15]
  ds_read_b64 v[22:23], v125
  s_waitcnt lgkmcnt(5)
  v_mfma_f32_4x4x4_16b_bf16 v[12:15], v[4:5], v[24:25], v[12:15]
  ds_read_b64 v[24:25], v126
  s_waitcnt lgkmcnt(5)
  v_mfma_f32_4x4x4_16b_bf16 v[12:15], v[4:5], v[26:27], v[12:15]
  ds_read_b64 v[26:27], v127
  s_mov_b64 exec, 1
  ds_add_u32 v10, v9 offset:12
  s_mov_b64 exec, -1
  s_waitcnt lgkmcnt(6)
  v_mfma_f32_4x4x4_16b_bf16 v[12:15], v[4:5], v[16:17], v[12:15]
  s_waitcnt lgkmcnt(5)
  s_nop 0
  v_mfma_f32_4x4x4_16b_bf16 v[12:15], v[4:5], v[18:19], v[12:15]
  s_waitcnt lgkmcnt(4)
  s_nop 0
  v_mfma_f32_4x4x4_16b_bf16 v[12:15], v[4:5], v[20:21], v[12:15]
  s_waitcnt lgkmcnt(3)
  s_nop 0
  v_mfma_f32_4x4x4_16b_bf16 v[12:15], v[4:5], v[22:23], v[12:15]
  s_waitcnt lgkmcnt(2)
  s_nop 0
  v_mfma_f32_4x4x4_16b_bf16 v[12:15], v[4:5], v[24:25], v[12:15]
  s_waitcnt lgkmcnt(1)
  s_nop 0
  v_mfma_f32_4x4x4_16b_bf16 v[12:15], v[4:5], v[26:27], v[12:15]
K3_TAIL0:
  s_setprio 3
  s_cmp_eq_u32 s21, 0
  s_cbranch_scc1 L_k3_27
  s_nop 1
  v_add_f32 v12, v12, v28
  v_add_f32 v13, v13, v29
  v_add_f32 v14, v14, v30
  v_add_f32 v15, v15, v31
L_k3_27:
  s_cmp_eq_u32 s18, 7
  s_cbranch_scc1 K3_LAST
  v_mul_f32 v16, v12, v8
  v_mul_f32 v17, v13, v8
  v_mul_f32 v18, v14, v8
  v_mul_f32 v19, v15, v8
  v_add_u32 v16, s17, v16
  v_add_u32 v18, s17, v18
  v_bfi_b32 v16, s31, v0, v16
  v_bfi_b32 v18, s31, v0, v18
  v_cvt_pk_bf16_f32 v16, v16, v17
  v_cvt_pk_bf16_f32 v17, v18, v19
  s_nop 1
  v_mov_b32_dpp v10, v17 quad_perm:[0,0,1,1] row_mask:0xf bank_mask:0xf
  v_mov_b32_dpp v11, v17 quad_perm:[2,2,3,3] row_mask:0xf bank_mask:0xf
  s_nop 0
  v_cndmask_b32_dpp v10, v16, v10, vcc quad_perm:[0,0,1,1] row_mask:0xf bank_mask:0xf
  v_cndmask_b32_dpp v11, v16, v11, vcc quad_perm:[2,2,3,3] row_mask:0xf bank_mask:0xf
  s_cmp_eq_u32 s20, 1
  s_cbranch_scc0 L_k3_28
  buffer_store_dwordx2 v[10:11], v1, s[12:15], s27 offen
L_k3_29:
  v_mul_f32 v12, v12, v3
  v_mul_f32 v13, v13, v3
  v_mul_f32 v14, v14, v3
  v_mul_f32 v15, v15, v3
  v_cvt_pk_bf16_f32 v30, v12, v13
  v_cvt_pk_bf16_f32 v31, v14, v15
  v_mov_b64 v[28:29], v[6:7]
  s_add_u32 s18, s18, 1
  s_add_u32 s46, s46, 16
  s_add_u32 s38, s38, 4
  s_xor_b64 s[12:13], s[12:13], s[24:25]
  s_bfe_i32 s16, s18, 0x10001
  s_andn2_b32 s17, 0x10000, s16
  v_lshlrev_b32 v0, 16, s16
  s_cmp_eq_u32 s18, 7
  s_cselect_b32 s20, 0, s20
  s_mov_b64 vcc, s[32:33]
  s_barrier
  s_branch K3_LOOP0
L_k3_9:
  v_mov_b32 v28, 125440
  ds_read_b32 v28, v28 offset:8
  s_waitcnt lgkmcnt(0)
  v_readfirstlane_b32 s37, v28
  s_cmp_ge_u32 s37, s18
  s_cbranch_scc1 L_k3_10
  s_sleep 1
  s_sub_u32 s19, s19, 1
  s_cbranch_scc0 L_k3_9
  s_mov_b32 s19, 0
  s_branch L_k3_10
L_k3_16:
  s_cmp_eq_u32 s20, 2
  s_cbranch_scc0 L_k3_17
  buffer_store_dwordx2 v[10:11], v1, s[12:15], s26 offen sc1
  s_branch L_k3_17
L_k3_18:
  v_mov_b32 v6, 125440
  ds_read_b32 v6, v6 offset:16
  s_waitcnt lgkmcnt(0)
  v_readfirstlane_b32 s37, v6
  s_cmp_ge_u32 s37, s38
  s_cbranch_scc1 L_k3_19
  s_sleep 1
  s_sub_u32 s19, s19, 1
  s_cbranch_scc0 L_k3_18
  s_mov_b32 s19, 0
  s_branch L_k3_19
L_k3_22:
  v_mov_b32 v28, 125440
  ds_read_b32 v28, v28 offset:8
  s_waitcnt lgkmcnt(0)
  v_readfirstlane_b32 s37, v28
  s_cmp_ge_u32 s37, s18
  s_cbranch_scc1 L_k3_23
  s_sleep 1
  s_sub_u32 s19, s19, 1
  s_cbranch_scc0 L_k3_22
  s_mov_b32 s19, 0
  s_branch L_k3_23
L_k3_25:
  s_cmp_eq_u32 s20, 2
  s_cbranch_scc0 L_k3_26
  buffer_store_dwordx2 v[10:11], v1, s[12:15], s26 offen sc1
  s_branch L_k3_26
L_k3_28:
  s_cmp_eq_u32 s20, 2
  s_cbranch_scc0 L_k3_29
  buffer_store_dwordx2 v[10:11], v1, s[12:15], s27 offen sc1
  s_branch L_k3_29
K3_LOOP1:
  s_setprio 2
  ds_read_b64 v[16:17], v32
  ds_read_b64 v[18:19], v33
  ds_read_b64 v[20:21], v34
  ds_read_b64 v[22:23], v35
  ds_read_b64 v[24:25], v36
  ds_read_b64 v[26:27], v37
  s_waitcnt lgkmcnt(5)
  v_mfma_f32_4x4x4_16b_bf16 v[8:11], v[4:5], v[16:17], 0
  ds_read_b64 v[16:17], v38
  s_waitcnt lgkmcnt(5)
  v_mfma_f32_4x4x4_16b_bf16 v[8:11], v[4:5], v[18:19], v[8:11]
  ds_read_b64 v[18:19], v39
  s_waitcnt lgkmcnt(5)
  v_mfma_f32_4x4x4_16b_bf16 v[8:11], v[4:5], v[20:21], v[8:11]
  ds_read_b64 v[20:21], v40
  s_waitcnt lgkmcnt(5)
  v_mfma_f32_4x4x4_16b_bf16 v[8:11], v[4:5], v[22:23], v[8:11]
  ds_read_b64 v[22:23], v41
  s_waitcnt lgkmcnt(5)
  v_mfma_f32_4x4x4_16b_bf16 v[8:11], v[4:5], v[24:25], v[8:11]
  ds_read_b64 v[24:25], v42
  s_waitcnt lgkmcnt(5)
  v_mfma_f32_4x4x4_16b_bf16 v[8:11], v[4:5], v[26:27], v[8:11]
  ds_read_b64 v[26:27], v43
  s_waitcnt lgkmcnt(5)
  v_mfma_f32_4x4x4_16b_bf16 v[8:11], v[4:5], v[16:17], v[8:11]
  ds_read_b64 v[16:17], v44
  s_waitcnt lgkmcnt(5)
  v_mfma_f32_4x4x4_16b_bf16 v[8:11], v[4:5], v[18:19], v[8:11]
  ds_read_b64 v[18:19], v45
  s_waitcnt lgkmcnt(5)
  v_mfma_f32_4x4x4_16b_bf16 v[8:11], v[4:5], v[20:21], v[8:11]
  ds_read_b64 v[20:21], v46
  buffer_store_dwordx4 v[28:31], v1, s[8:11], s22 offen sc1
  s_add_u32 s22, s22, 3211264
  s_waitcnt lgkmcnt(5)
  v_mfma_f32_4x4x4_16b_bf16 v[8:11], v[4:5], v[22:23], v[8:11]
  ds_read_b64 v[22:23], v47
  s_waitcnt lgkmcnt(5)
  v_mfma_f32_4x4x4_16b_bf16 v[8:11], v[4:5], v[24:25], v[8:11]
  ds_read_b64 v[24:25], v48
  s_waitcnt lgkmcnt(5)
  v_mfma_f32_4x4x4_16b_bf16 v[8:11], v[4:5], v[26:27], v[8:11]
  ds_read_b64 v[26:27], v49
  s_waitcnt lgkmcnt(5)
  v_mfma_f32_4x4x4_16b_bf16 v[8:11], v[4:5], v[16:17], v[8:11]
  ds_read_b64 v[16:17], v50
  s_waitcnt lgkmcnt(5)
  v_mfma_f32_4x4x4_16b_bf16 v[8:11], v[4:5], v[18:19], v[8:11]
  ds_read_b64 v[18:19], v51
  s_waitcnt lgkmcnt(5)
  v_mfma_f32_4x4x4_16b_bf16 v[8:11], v[4:5], v[20:21], v[8:11]
  ds_read_b64 v[20:21], v52
  s_waitcnt lgkmcnt(5)
  v_mfma_f32_4x4x4_16b_bf16 v[8:11], v[4:5], v[22:23], v[8:11]
  ds_read_b64 v[22:23], v53
  s_waitcnt lgkmcnt(5)
  v_mfma_f32_4x4x4_16b_bf16 v[12:15], v[4:5], v[24:25], 0
  ds_read_b64 v[24:25], v54
  s_waitcnt lgkmcnt(5)
  v_mfma_f32_4x4x4_16b_bf16 v[12:15], v[4:5], v[26:27], v[12:15]
  ds_read_b64 v[26:27], v55
  s_waitcnt lgkmcnt(5)
  v_mfma_f32_4x4x4_16b_bf16 v[12:15], v[4:5], v[16:17], v[12:15]
  ds_read_b64 v[16:17], v56
  s_waitcnt lgkmcnt(5)
  v_mfma_f32_4x4x4_16b_bf16 v[12:15], v[4:5], v[18:19], v[12:15]
  ds_read_b64 v[18:19], v57
  v_mov_b32 v6, 125440
  ds_read_b32 v6, v6 offset:16
  s_waitcnt lgkmcnt(5)
  v_mfma_f32_4x4x4_16b_bf16 v[12:15], v[4:5], v[20:21], v[12:15]
  ds_read_b64 v[20:21], v58
  s_waitcnt lgkmcnt(5)
  v_mfma_f32_4x4x4_16b_bf16 v[12:15], v[4:5], v[22:23], v[12:15]
  ds_read_b64 v[22:23], v59
  s_waitcnt lgkmcnt(5)
  v_mfma_f32_4x4x4_16b_bf16 v[12:15], v[4:5], v[24:25], v[12:15]
  ds_read_b64 v[24:25], v60
  s_waitcnt lgkmcnt(5)
  v_mfma_f32_4x4x4_16b_bf16 v[12:15], v[4:5], v[26:27], v[12:15]
  ds_read_b64 v[26:27], v61
  s_waitcnt lgkmcnt(5)
  v_mfma_f32_4x4x4_16b_bf16 v[12:15], v[4:5], v[16:17], v[12:15]
  ds_read_b64 v[16:17], v62
  s_waitcnt lgkmcnt(5)
  v_mfma_f32_4x4x4_16b_bf16 v[12:15], v[4:5], v[18:19], v[12:15]
  ds_read_b64 v[18:19], v63
  v_readfirstlane_b32 s37, v6
  s_cmp_ge_u32 s37, s38
  s_cbranch_scc0 L_k3_30
L_k3_31:
  s_waitcnt lgkmcnt(5)
  v_mfma_f32_4x4x4_16b_bf16 v[12:15], v[4:5], v[20:21], v[12:15]
  ds_read_b64 v[20:21], v64
  s_waitcnt lgkmcnt(5)
  v_mfma_f32_4x4x4_16b_bf16 v[12:15], v[4:5], v[22:23], v[12:15]
  ds_read_b64 v[22:23], v65
  s_waitcnt lgkmcnt(5)
  v_mfma_f32_4x4x4_16b_bf16 v[12:15], v[4:5], v[24:25], v[12:15]
  ds_read_b64 v[24:25], v66
  s_waitcnt lgkmcnt(5)
  v_mfma_f32_4x4x4_16b_bf16 v[12:15], v[4:5], v[26:27], v[12:15]
  ds_read_b64 v[26:27], v67
  s_waitcnt lgkmcnt(5)
  v_mfma_f32_4x4x4_16b_bf16 v[12:15], v[4:5], v[16:17], v[12:15]
  ds_read_b64 v[16:17], v68
  s_waitcnt lgkmcnt(5)
  v_mfma_f32_4x4x4_16b_bf16 v[12:15], v[4:5], v[18:19], v[12:15]
  ds_read_b64 v[18:19], v69
  s_waitcnt lgkmcnt(5)
  v_mfma_f32_4x4x4_16b_bf16 v[8:11], v[4:5], v[20:21], v[8:11]
  ds_read_b64 v[20:21], v70
  s_waitcnt lgkmcnt(5)
  v_mfma_f32_4x4x4_16b_bf16 v[8:11], v[4:5], v[22:23], v[8:11]
  ds_read_b64 v[22:23], v71
  s_waitcnt lgkmcnt(5)
  v_mfma_f32_4x4x4_16b_bf16 v[8:11], v[4:5], v[24:25], v[8:11]
  ds_read_b64 v[24:25], v72
  s_waitcnt lgkmcnt(5)
  v_mfma_f32_4x4x4_16b_bf16 v[8:11], v[4:5], v[26:27], v[8:11]
  ds_read_b64 v[26:27], v73
  s_waitcnt lgkmcnt(5)
  v_mfma_f32_4x4x4_16b_bf16 v[8:11], v[4:5], v[16:17], v[8:11]
  ds_read_b64 v[16:17], v74
  s_waitcnt lgkmcnt(5)
  v_mfma_f32_4x4x4_16b_bf16 v[8:11], v[4:5], v[18:19], v[8:11]
  ds_read_b64 v[18:19], v75
  s_waitcnt lgkmcnt(5)
  v_mfma_f32_4x4x4_16b_bf16 v[8:11], v[4:5], v[20:21], v[8:11]
  ds_read_b64 v[20:21], v76
  s_waitcnt lgkmcnt(5)
  v_mfma_f32_4x4x4_16b_bf16 v[8:11], v[4:5], v[22:23], v[8:11]
  ds_read_b64 v[22:23], v77
  s_waitcnt lgkmcnt(5)
  v_mfma_f32_4x4x4_16b_bf16 v[8:11], v[4:5], v[24:25], v[8:11]
  ds_read_b64 v[24:25], v78
  s_waitcnt lgkmcnt(5)
  v_mfma_f32_4x4x4_16b_bf16 v[8:11], v[4:5], v[26:27], v[8:11]
  ds_read_b64 v[26:27], v79
  s_waitcnt lgkmcnt(5)
  v_mfma_f32_4x4x4_16b_bf16 v[8:11], v[4:5], v[16:17], v[8:11]
  ds_read_b64 v[16:17], v80
  s_waitcnt lgkmcnt(5)
  v_mfma_f32_4x4x4_16b_bf16 v[8:11], v[4:5], v[18:19], v[8:11]
  ds_read_b64 v[18:19], v81
  s_waitcnt lgkmcnt(5)
  v_mfma_f32_4x4x4_16b_bf16 v[8:11], v[4:5], v[20:21], v[8:11]
  ds_read_b64 v[20:21], v82
  s_waitcnt lgkmcnt(5)
  v_mfma_f32_4x4x4_16b_bf16 v[8:11], v[4:5], v[22:23], v[8:11]
  ds_read_b64 v[22:23], v83
  s_waitcnt lgkmcnt(5)
  v_mfma_f32_4x4x4_16b_bf16 v[8:11], v[4:5], v[24:25], v[8:11]
  ds_read_b64 v[24:25], v84
  s_waitcnt lgkmcnt(5)
  v_mfma_f32_4x4x4_16b_bf16 v[8:11], v[4:5], v[26:27], v[8:11]
  ds_read_b64 v[26:27], v85
  s_waitcnt lgkmcnt(5)
  v_mfma_f32_4x4x4_16b_bf16 v[8:11], v[4:5], v[16:17], v[8:11]
  ds_read_b64 v[16:17], v86
  s_waitcnt lgkmcnt(5)
  v_mfma_f32_4x4x4_16b_bf16 v[8:11], v[4:5], v[18:19], v[8:11]
  ds_read_b64 v[18:19], v87
  s_waitcnt lgkmcnt(5)
  v_mfma_f32_4x4x4_16b_bf16 v[8:11], v[4:5], v[20:21], v[8:11]
  ds_read_b64 v[20:21], v88
  s_waitcnt lgkmcnt(5)
  v_mfma_f32_4x4x4_16b_bf16 v[8:11], v[4:5], v[22:23], v[8:11]
  ds_read_b64 v[22:23], v89
  s_waitcnt lgkmcnt(5)
  v_mfma_f32_4x4x4_16b_bf16 v[8:11], v[4:5], v[24:25], v[8:11]
  ds_read_b64 v[24:25], v90
  s_waitcnt lgkmcnt(5)
  v_mfma_f32_4x4x4_16b_bf16 v[8:11], v[4:5], v[26:27], v[8:11]
  ds_read_b64 v[26:27], v91
  s_cmp_eq_u32 s21, 0
  s_cbranch_scc1 L_k3_32
  v_mov_b32 v28, 125440
  ds_read_b32 v28, v28 offset:8
L_k3_32:
  s_waitcnt lgkmcnt(5)
  v_mfma_f32_4x4x4_16b_bf16 v[8:11], v[4:5], v[16:17], v[8:11]
  ds_read_b64 v[16:17], v92
  s_waitcnt lgkmcnt(5)
  v_mfma_f32_4x4x4_16b_bf16 v[8:11], v[4:5], v[18:19], v[8:11]
  ds_read_b64 v[18:19], v93
  s_waitcnt lgkmcnt(5)
  v_mfma_f32_4x4x4_16b_bf16 v[8:11], v[4:5], v[20:21], v[8:11]
  ds_read_b64 v[20:21], v94
  s_waitcnt lgkmcnt(5)
  v_mfma_f32_4x4x4_16b_bf16 v[8:11], v[4:5], v[22:23], v[8:11]
  ds_read_b64 v[22:23], v95
  s_waitcnt lgkmcnt(5)
  v_mfma_f32_4x4x4_16b_bf16 v[8:11], v[4:5], v[24:25], v[8:11]
  ds_read_b64 v[24:25], v96
  s_waitcnt lgkmcnt(5)
  v_mfma_f32_4x4x4_16b_bf16 v[8:11], v[4:5], v[26:27], v[8:11]
  ds_read_b64 v[26:27], v97
  s_cmp_eq_u32 s21, 0
  s_cbranch_scc1 L_k3_33
  v_readfirstlane_b32 s37, v28
  s_cmp_ge_u32 s37, s18
  s_cbranch_scc0 L_k3_34
L_k3_35:
  v_add_u32 v28, s30, v1
  ds_read_b128 v[28:31], v28
L_k3_33:
  s_waitcnt lgkmcnt(5)
  v_mfma_f32_4x4x4_16b_bf16 v[8:11], v[4:5], v[16:17], v[8:11]
  ds_read_b64 v[16:17], v98
  s_waitcnt lgkmcnt(5)
  v_mfma_f32_4x4x4_16b_bf16 v[8:11], v[4:5], v[18:19], v[8:11]
  ds_read_b64 v[18:19], v99
  s_waitcnt lgkmcnt(5)
  v_mfma_f32_4x4x4_16b_bf16 v[8:11], v[4:5], v[20:21], v[8:11]
  ds_read_b64 v[20:21], v100
  s_waitcnt lgkmcnt(5)
  v_mfma_f32_4x4x4_16b_bf16 v[8:11], v[4:5], v[22:23], v[8:11]
  ds_read_b64 v[22:23], v101
  s_waitcnt lgkmcnt(5)
  v_mfma_f32_4x4x4_16b_bf16 v[12:15], v[4:5], v[24:25], v[12:15]
  ds_read_b64 v[24:25], v102
  s_waitcnt lgkmcnt(5)
  v_mfma_f32_4x4x4_16b_bf16 v[12:15], v[4:5], v[26:27], v[12:15]
  ds_read_b64 v[26:27], v103
  s_cmp_eq_u32 s21, 0
  s_cbranch_scc1 L_k3_36
  v_add_f32 v8, v8, v28
  v_add_f32 v9, v9, v29
  v_add_f32 v10, v10, v30
  v_add_f32 v11, v11, v31
  v_add_u32 v28, s30, v1
  ds_read_b128 v[28:31], v28 offset:1024
L_k3_36:
  s_waitcnt lgkmcnt(5)
  v_mfma_f32_4x4x4_16b_bf16 v[12:15], v[4:5], v[16:17], v[12:15]
  ds_read_b64 v[16:17], v104
  v_mul_f32 v8, v8, v2
  v_mul_f32 v9, v9, v2
  v_mul_f32 v10, v10, v2
  v_mul_f32 v11, v11, v2
  v_cvt_pk_bf16_f32 v6, v8, v9
  v_cvt_pk_bf16_f32 v7, v10, v11
  v_mul_f32 v8, v8, v2
  v_mul_f32 v9, v9, v2
  v_mul_f32 v10, v10, v2
  v_mul_f32 v11, v11, v2
  v_add_u32 v8, s17, v8
  v_add_u32 v10, s17, v10
  v_bfi_b32 v8, s31, v0, v8
  v_bfi_b32 v10, s31, v0, v10
  v_cvt_pk_bf16_f32 v8, v8, v9
  v_cvt_pk_bf16_f32 v9, v10, v11
  s_nop 1
  v_mov_b32_dpp v10, v9 quad_perm:[0,0,1,1] row_mask:0xf bank_mask:0xf
  v_mov_b32_dpp v11, v9 quad_perm:[2,2,3,3] row_mask:0xf bank_mask:0xf
  s_nop 0
  v_cndmask_b32_dpp v10, v8, v10, vcc quad_perm:[0,0,1,1] row_mask:0xf bank_mask:0xf
  v_cndmask_b32_dpp v11, v8, v11, vcc quad_perm:[2,2,3,3] row_mask:0xf bank_mask:0xf
  s_waitcnt lgkmcnt(5)
  v_mfma_f32_4x4x4_16b_bf16 v[12:15], v[4:5], v[18:19], v[12:15]
  ds_read_b64 v[18:19], v105
  s_setprio 0
  s_cmp_eq_u32 s20, 1
  s_cbranch_scc0 L_k3_37
  buffer_store_dwordx2 v[10:11], v1, s[12:15], s26 offen
L_k3_38:
  s_waitcnt lgkmcnt(5)
  v_mfma_f32_4x4x4_16b_bf16 v[12:15], v[4:5], v[20:21], v[12:15]
  ds_read_b64 v[20:21], v106
  v_mul_f32 v8, v3, v3
  s_waitcnt lgkmcnt(5)
  v_mfma_f32_4x4x4_16b_bf16 v[12:15], v[4:5], v[22:23], v[12:15]
  ds_read_b64 v[22:23], v107
  s_waitcnt lgkmcnt(5)
  v_mfma_f32_4x4x4_16b_bf16 v[12:15], v[4:5], v[24:25], v[12:15]
  ds_read_b64 v[24:25], v108
  s_waitcnt lgkmcnt(5)
  v_mfma_f32_4x4x4_16b_bf16 v[12:15], v[4:5], v[26:27], v[12:15]
  ds_read_b64 v[26:27], v109
  v_mov_b32 v9, 1
  v_mov_b32 v10, 125440
  s_waitcnt lgkmcnt(5)
  v_mfma_f32_4x4x4_16b_bf16 v[12:15], v[4:5], v[16:17], v[12:15]
  ds_read_b64 v[16:17], v110
  s_waitcnt lgkmcnt(5)
  v_mfma_f32_4x4x4_16b_bf16 v[12:15], v[4:5], v[18:19], v[12:15]
  ds_read_b64 v[18:19], v111
  s_waitcnt lgkmcnt(5)
  v_mfma_f32_4x4x4_16b_bf16 v[12:15], v[4:5], v[20:21], v[12:15]
  ds_read_b64 v[20:21], v112
  s_waitcnt lgkmcnt(5)
  v_mfma_f32_4x4x4_16b_bf16 v[12:15], v[4:5], v[22:23], v[12:15]
  ds_read_b64 v[22:23], v113
  s_waitcnt lgkmcnt(5)
  v_mfma_f32_4x4x4_16b_bf16 v[12:15], v[4:5], v[24:25], v[12:15]
  ds_read_b64 v[24:25], v114
  s_waitcnt lgkmcnt(5)
  v_mfma_f32_4x4x4_16b_bf16 v[12:15], v[4:5], v[26:27], v[12:15]
  ds_read_b64 v[26:27], v115
  s_waitcnt lgkmcnt(5)
  v_mfma_f32_4x4x4_16b_bf16 v[12:15], v[4:5], v[16:17], v[12:15]
  ds_read_b64 v[16:17], v116
  s_waitcnt lgkmcnt(5)
  v_mfma_f32_4x4x4_16b_bf16 v[12:15], v[4:5], v[18:19], v[12:15]
  ds_read_b64 v[18:19], v117
  s_waitcnt lgkmcnt(5)
  v_mfma_f32_4x4x4_16b_bf16 v[12:15], v[4:5], v[20:21], v[12:15]
  ds_read_b64 v[20:21], v118
  s_waitcnt lgkmcnt(5)
  v_mfma_f32_4x4x4_16b_bf16 v[12:15], v[4:5], v[22:23], v[12:15]
  ds_read_b64 v[22:23], v119
  s_waitcnt lgkmcnt(5)
  v_mfma_f32_4x4x4_16b_bf16 v[12:15], v[4:5], v[24:25], v[12:15]
  ds_read_b64 v[24:25], v120
  s_waitcnt lgkmcnt(5)
  v_mfma_f32_4x4x4_16b_bf16 v[12:15], v[4:5], v[26:27], v[12:15]
  ds_read_b64 v[26:27], v121
  s_waitcnt lgkmcnt(5)
  v_mfma_f32_4x4x4_16b_bf16 v[12:15], v[4:5], v[16:17], v[12:15]
  ds_read_b64 v[16:17], v122
  s_waitcnt lgkmcnt(5)
  v_mfma_f32_4x4x4_16b_bf16 v[12:15], v[4:5], v[18:19], v[12:15]
  ds_read_b64 v[18:19], v123
  s_waitcnt lgkmcnt(5)
  v_mfma_f32_4x4x4_16b_bf16 v[12:15], v[4:5], v[20:21], v[12:15]
  ds_read_b64 v[20:21], v124
  s_waitcnt lgkmcnt(5)
  v_mfma_f32_4x4x4_16b_bf16 v[12:15], v[4:5], v[22:23], v[12:15]
  ds_read_b64 v[22:23], v125
  s_waitcnt lgkmcnt(5)
  v_mfma_f32_4x4x4_16b_bf16 v[12:15], v[4:5], v[24:25], v[12:15]
  ds_read_b64 v[24:25], v126
  s_waitcnt lgkmcnt(5)
  v_mfma_f32_4x4x4_16b_bf16 v[12:15], v[4:5], v[26:27], v[12:15]
  ds_read_b64 v[26:27], v127
  s_mov_b64 exec, 1
  ds_add_u32 v10, v9 offset:12
  s_mov_b64 exec, -1
  s_waitcnt lgkmcnt(6)
  v_mfma_f32_4x4x4_16b_bf16 v[12:15], v[4:5], v[16:17], v[12:15]
  s_waitcnt lgkmcnt(5)
  s_nop 0
  v_mfma_f32_4x4x4_16b_bf16 v[12:15], v[4:5], v[18:19], v[12:15]
  s_waitcnt lgkmcnt(4)
  s_nop 0
  v_mfma_f32_4x4x4_16b_bf16 v[12:15], v[4:5], v[20:21], v[12:15]
  s_waitcnt lgkmcnt(3)
  s_nop 0
  v_mfma_f32_4x4x4_16b_bf16 v[12:15], v[4:5], v[22:23], v[12:15]
  s_waitcnt lgkmcnt(2)
  s_nop 0
  v_mfma_f32_4x4x4_16b_bf16 v[12:15], v[4:5], v[24:25], v[12:15]
  s_waitcnt lgkmcnt(1)
  s_nop 0
  v_mfma_f32_4x4x4_16b_bf16 v[12:15], v[4:5], v[26:27], v[12:15]
K3_TAIL1:
  s_setprio 3
  s_cmp_eq_u32 s21, 0
  s_cbranch_scc1 L_k3_39
  s_nop 1
  v_add_f32 v12, v12, v28
  v_add_f32 v13, v13, v29
  v_add_f32 v14, v14, v30
  v_add_f32 v15, v15, v31
L_k3_39:
  s_cmp_eq_u32 s18, 7
  s_cbranch_scc1 K3_LAST
  v_mul_f32 v16, v12, v8
  v_mul_f32 v17, v13, v8
  v_mul_f32 v18, v14, v8
  v_mul_f32 v19, v15, v8
  v_add_u32 v16, s17, v16
  v_add_u32 v18, s17, v18
  v_bfi_b32 v16, s31, v0, v16
  v_bfi_b32 v18, s31, v0, v18
  v_cvt_pk_bf16_f32 v16, v16, v17
  v_cvt_pk_bf16_f32 v17, v18, v19
  s_nop 1
  v_mov_b32_dpp v10, v17 quad_perm:[0,0,1,1] row_mask:0xf bank_mask:0xf
  v_mov_b32_dpp v11, v17 quad_perm:[2,2,3,3] row_mask:0xf bank_mask:0xf
  s_nop 0
  v_cndmask_b32_dpp v10, v16, v10, vcc quad_perm:[0,0,1,1] row_mask:0xf bank_mask:0xf
  v_cndmask_b32_dpp v11, v16, v11, vcc quad_perm:[2,2,3,3] row_mask:0xf bank_mask:0xf
  s_cmp_eq_u32 s20, 1
  s_cbranch_scc0 L_k3_40
  buffer_store_dwordx2 v[10:11], v1, s[12:15], s27 offen
L_k3_41:
  v_mul_f32 v12, v12, v3
  v_mul_f32 v13, v13, v3
  v_mul_f32 v14, v14, v3
  v_mul_f32 v15, v15, v3
  v_cvt_pk_bf16_f32 v30, v12, v13
  v_cvt_pk_bf16_f32 v31, v14, v15
  v_mov_b64 v[28:29], v[6:7]
  s_add_u32 s18, s18, 1
  s_add_u32 s46, s46, 16
  s_add_u32 s38, s38, 4
  s_xor_b64 s[12:13], s[12:13], s[24:25]
  s_bfe_i32 s16, s18, 0x10001
  s_andn2_b32 s17, 0x10000, s16
  v_lshlrev_b32 v0, 16, s16
  s_cmp_eq_u32 s18, 7
  s_cselect_b32 s20, 0, s20
  s_mov_b64 vcc, s[32:33]
  s_barrier
  s_branch K3_LOOP1
L_k3_30:
  v_mov_b32 v6, 125440
  ds_read_b32 v6, v6 offset:16
  s_waitcnt lgkmcnt(0)
  v_readfirstlane_b32 s37, v6
  s_cmp_ge_u32 s37, s38
  s_cbranch_scc1 L_k3_31
  s_sleep 1
  s_sub_u32 s19, s19, 1
  s_cbranch_scc0 L_k3_30
  s_mov_b32 s19, 0
  s_branch L_k3_31
L_k3_34:
  v_mov_b32 v28, 125440
  ds_read_b32 v28, v28 offset:8
  s_waitcnt lgkmcnt(0)
  v_readfirstlane_b32 s37, v28
  s_cmp_ge_u32 s37, s18
  s_cbranch_scc1 L_k3_35
  s_sleep 1
  s_sub_u32 s19, s19, 1
  s_cbranch_scc0 L_k3_34
  s_mov_b32 s19, 0
  s_branch L_k3_35
L_k3_37:
  s_cmp_eq_u32 s20, 2
  s_cbranch_scc0 L_k3_38
  buffer_store_dwordx2 v[10:11], v1, s[12:15], s26 offen sc1
  s_branch L_k3_38
L_k3_40:
  s_cmp_eq_u32 s20, 2
  s_cbranch_scc0 L_k3_41
  buffer_store_dwordx2 v[10:11], v1, s[12:15], s27 offen sc1
  s_branch L_k3_41
K3_LOOP2:
  s_setprio 2
  ds_read_b64 v[16:17], v32
  ds_read_b64 v[18:19], v33
  ds_read_b64 v[20:21], v34
  ds_read_b64 v[22:23], v35
  ds_read_b64 v[24:25], v36
  ds_read_b64 v[26:27], v37
  s_waitcnt lgkmcnt(5)
  v_mfma_f32_4x4x4_16b_bf16 v[8:11], v[4:5], v[16:17], 0
  ds_read_b64 v[16:17], v38
  s_waitcnt lgkmcnt(5)
  v_mfma_f32_4x4x4_16b_bf16 v[8:11], v[4:5], v[18:19], v[8:11]
  ds_read_b64 v[18:19], v39
  s_waitcnt lgkmcnt(5)
  v_mfma_f32_4x4x4_16b_bf16 v[8:11], v[4:5], v[20:21], v[8:11]
  ds_read_b64 v[20:21], v40
  s_waitcnt lgkmcnt(5)
  v_mfma_f32_4x4x4_16b_bf16 v[8:11], v[4:5], v[22:23], v[8:11]
  ds_read_b64 v[22:23], v41
  s_waitcnt lgkmcnt(5)
  v_mfma_f32_4x4x4_16b_bf16 v[8:11], v[4:5], v[24:25], v[8:11]
  ds_read_b64 v[24:25], v42
  s_waitcnt lgkmcnt(5)
  v_mfma_f32_4x4x4_16b_bf16 v[8:11], v[4:5], v[26:27], v[8:11]
  ds_read_b64 v[26:27], v43
  s_waitcnt lgkmcnt(5)
  v_mfma_f32_4x4x4_16b_bf16 v[8:11], v[4:5], v[16:17], v[8:11]
  ds_read_b64 v[16:17], v44
  s_waitcnt lgkmcnt(5)
  v_mfma_f32_4x4x4_16b_bf16 v[8:11], v[4:5], v[18:19], v[8:11]
  ds_read_b64 v[18:19], v45
  s_waitcnt lgkmcnt(5)
  v_mfma_f32_4x4x4_16b_bf16 v[8:11], v[4:5], v[20:21], v[8:11]
  ds_read_b64 v[20:21], v46
  buffer_store_dwordx4 v[28:31], v1, s[8:11], s22 offen sc1
  s_add_u32 s22, s22, 3211264
  s_waitcnt lgkmcnt(5)
  v_mfma_f32_4x4x4_16b_bf16 v[8:11], v[4:5], v[22:23], v[8:11]
  ds_read_b64 v[22:23], v47
  s_waitcnt lgkmcnt(5)
  v_mfma_f32_4x4x4_16b_bf16 v[8:11], v[4:5], v[24:25], v[8:11]
  ds_read_b64 v[24:25], v48
  s_waitcnt lgkmcnt(5)
  v_mfma_f32_4x4x4_16b_bf16 v[8:11], v[4:5], v[26:27], v[8:11]
  ds_read_b64 v[26:27], v49
  s_waitcnt lgkmcnt(5)
  v_mfma_f32_4x4x4_16b_bf16 v[8:11], v[4:5], v[16:17], v[8:11]
  ds_read_b64 v[16:17], v50
  s_waitcnt lgkmcnt(5)
  v_mfma_f32_4x4x4_16b_bf16 v[8:11], v[4:5], v[18:19], v[8:11]
  ds_read_b64 v[18:19], v51
  s_waitcnt lgkmcnt(5)
  v_mfma_f32_4x4x4_16b_bf16 v[8:11], v[4:5], v[20:21], v[8:11]
  ds_read_b64 v[20:21], v52
  s_waitcnt lgkmcnt(5)
  v_mfma_f32_4x4x4_16b_bf16 v[8:11], v[4:5], v[22:23], v[8:11]
  ds_read_b64 v[22:23], v53
  s_waitcnt lgkmcnt(5)
  v_mfma_f32_4x4x4_16b_bf16 v[12:15], v[4:5], v[24:25], 0
  ds_read_b64 v[24:25], v54
  s_waitcnt lgkmcnt(5)
  v_mfma_f32_4x4x4_16b_bf16 v[12:15], v[4:5], v[26:27], v[12:15]
  ds_read_b64 v[26:27], v55
  s_waitcnt lgkmcnt(5)
  v_mfma_f32_4x4x4_16b_bf16 v[12:15], v[4:5], v[16:17], v[12:15]
  ds_read_b64 v[16:17], v56
  s_waitcnt lgkmcnt(5)
  v_mfma_f32_4x4x4_16b_bf16 v[12:15], v[4:5], v[18:19], v[12:15]
  ds_read_b64 v[18:19], v57
  v_mov_b32 v6, 125440
  ds_read_b32 v6, v6 offset:16
  s_waitcnt lgkmcnt(5)
  v_mfma_f32_4x4x4_16b_bf16 v[12:15], v[4:5], v[20:21], v[12:15]
  ds_read_b64 v[20:21], v58
  s_waitcnt lgkmcnt(5)
  v_mfma_f32_4x4x4_16b_bf16 v[12:15], v[4:5], v[22:23], v[12:15]
  ds_read_b64 v[22:23], v59
  s_waitcnt lgkmcnt(5)
  v_mfma_f32_4x4x4_16b_bf16 v[12:15], v[4:5], v[24:25], v[12:15]
  ds_read_b64 v[24:25], v60
  s_waitcnt lgkmcnt(5)
  v_mfma_f32_4x4x4_16b_bf16 v[12:15], v[4:5], v[26:27], v[12:15]
  ds_read_b64 v[26:27], v61
  s_waitcnt lgkmcnt(5)
  v_mfma_f32_4x4x4_16b_bf16 v[12:15], v[4:5], v[16:17], v[12:15]
  ds_read_b64 v[16:17], v62
  s_waitcnt lgkmcnt(5)
  v_mfma_f32_4x4x4_16b_bf16 v[12:15], v[4:5], v[18:19], v[12:15]
  ds_read_b64 v[18:19], v63
  v_readfirstlane_b32 s37, v6
  s_cmp_ge_u32 s37, s38
  s_cbranch_scc0 L_k3_42
L_k3_43:
  s_waitcnt lgkmcnt(5)
  v_mfma_f32_4x4x4_16b_bf16 v[12:15], v[4:5], v[20:21], v[12:15]
  ds_read_b64 v[20:21], v64
  s_waitcnt lgkmcnt(5)
  v_mfma_f32_4x4x4_16b_bf16 v[12:15], v[4:5], v[22:23], v[12:15]
  ds_read_b64 v[22:23], v65
  s_waitcnt lgkmcnt(5)
  v_mfma_f32_4x4x4_16b_bf16 v[12:15], v[4:5], v[24:25], v[12:15]
  ds_read_b64 v[24:25], v66
  s_waitcnt lgkmcnt(5)
  v_mfma_f32_4x4x4_16b_bf16 v[12:15], v[4:5], v[26:27], v[12:15]
  ds_read_b64 v[26:27], v67
  s_waitcnt lgkmcnt(5)
  v_mfma_f32_4x4x4_16b_bf16 v[12:15], v[4:5], v[16:17], v[12:15]
  ds_read_b64 v[16:17], v68
  s_waitcnt lgkmcnt(5)
  v_mfma_f32_4x4x4_16b_bf16 v[12:15], v[4:5], v[18:19], v[12:15]
  ds_read_b64 v[18:19], v69
  s_waitcnt lgkmcnt(5)
  v_mfma_f32_4x4x4_16b_bf16 v[8:11], v[4:5], v[20:21], v[8:11]
  ds_read_b64 v[20:21], v70
  s_waitcnt lgkmcnt(5)
  v_mfma_f32_4x4x4_16b_bf16 v[8:11], v[4:5], v[22:23], v[8:11]
  ds_read_b64 v[22:23], v71
  s_waitcnt lgkmcnt(5)
  v_mfma_f32_4x4x4_16b_bf16 v[8:11], v[4:5], v[24:25], v[8:11]
  ds_read_b64 v[24:25], v72
  s_waitcnt lgkmcnt(5)
  v_mfma_f32_4x4x4_16b_bf16 v[8:11], v[4:5], v[26:27], v[8:11]
  ds_read_b64 v[26:27], v73
  s_waitcnt lgkmcnt(5)
  v_mfma_f32_4x4x4_16b_bf16 v[8:11], v[4:5], v[16:17], v[8:11]
  ds_read_b64 v[16:17], v74
  s_waitcnt lgkmcnt(5)
  v_mfma_f32_4x4x4_16b_bf16 v[8:11], v[4:5], v[18:19], v[8:11]
  ds_read_b64 v[18:19], v75
  s_waitcnt lgkmcnt(5)
  v_mfma_f32_4x4x4_16b_bf16 v[8:11], v[4:5], v[20:21], v[8:11]
  ds_read_b64 v[20:21], v76
  s_waitcnt lgkmcnt(5)
  v_mfma_f32_4x4x4_16b_bf16 v[8:11], v[4:5], v[22:23], v[8:11]
  ds_read_b64 v[22:23], v77
  s_waitcnt lgkmcnt(5)
  v_mfma_f32_4x4x4_16b_bf16 v[8:11], v[4:5], v[24:25], v[8:11]
  ds_read_b64 v[24:25], v78
  s_waitcnt lgkmcnt(5)
  v_mfma_f32_4x4x4_16b_bf16 v[8:11], v[4:5], v[26:27], v[8:11]
  ds_read_b64 v[26:27], v79
  s_waitcnt lgkmcnt(5)
  v_mfma_f32_4x4x4_16b_bf16 v[8:11], v[4:5], v[16:17], v[8:11]
  ds_read_b64 v[16:17], v80
  s_waitcnt lgkmcnt(5)
  v_mfma_f32_4x4x4_16b_bf16 v[8:11], v[4:5], v[18:19], v[8:11]
  ds_read_b64 v[18:19], v81
  s_waitcnt lgkmcnt(5)
  v_mfma_f32_4x4x4_16b_bf16 v[8:11], v[4:5], v[20:21], v[8:11]
  ds_read_b64 v[20:21], v82
  s_waitcnt lgkmcnt(5)
  v_mfma_f32_4x4x4_16b_bf16 v[8:11], v[4:5], v[22:23], v[8:11]
  ds_read_b64 v[22:23], v83
  s_waitcnt lgkmcnt(5)
  v_mfma_f32_4x4x4_16b_bf16 v[8:11], v[4:5], v[24:25], v[8:11]
  ds_read_b64 v[24:25], v84
  s_waitcnt lgkmcnt(5)
  v_mfma_f32_4x4x4_16b_bf16 v[8:11], v[4:5], v[26:27], v[8:11]
  ds_read_b64 v[26:27], v85
  s_waitcnt lgkmcnt(5)
  v_mfma_f32_4x4x4_16b_bf16 v[8:11], v[4:5], v[16:17], v[8:11]
  ds_read_b64 v[16:17], v86
  s_waitcnt lgkmcnt(5)
  v_mfma_f32_4x4x4_16b_bf16 v[8:11], v[4:5], v[18:19], v[8:11]
  ds_read_b64 v[18:19], v87
  s_waitcnt lgkmcnt(5)
  v_mfma_f32_4x4x4_16b_bf16 v[8:11], v[4:5], v[20:21], v[8:11]
  ds_read_b64 v[20:21], v88
  s_waitcnt lgkmcnt(5)
  v_mfma_f32_4x4x4_16b_bf16 v[8:11], v[4:5], v[22:23], v[8:11]
  ds_read_b64 v[22:23], v89
  s_waitcnt lgkmcnt(5)
  v_mfma_f32_4x4x4_16b_bf16 v[8:11], v[4:5], v[24:25], v[8:11]
  ds_read_b64 v[24:25], v90
  s_waitcnt lgkmcnt(5)
  v_mfma_f32_4x4x4_16b_bf16 v[8:11], v[4:5], v[26:27], v[8:11]
  ds_read_b64 v[26:27], v91
  s_cmp_eq_u32 s21, 0
  s_cbranch_scc1 L_k3_44
  v_mov_b32 v28, 125440
  ds_read_b32 v28, v28 offset:8
L_k3_44:
  s_waitcnt lgkmcnt(5)
  v_mfma_f32_4x4x4_16b_bf16 v[8:11], v[4:5], v[16:17], v[8:11]
  ds_read_b64 v[16:17], v92
  s_waitcnt lgkmcnt(5)
  v_mfma_f32_4x4x4_16b_bf16 v[8:11], v[4:5], v[18:19], v[8:11]
  ds_read_b64 v[18:19], v93
  s_waitcnt lgkmcnt(5)
  v_mfma_f32_4x4x4_16b_bf16 v[8:11], v[4:5], v[20:21], v[8:11]
  ds_read_b64 v[20:21], v94
  s_waitcnt lgkmcnt(5)
  v_mfma_f32_4x4x4_16b_bf16 v[8:11], v[4:5], v[22:23], v[8:11]
  ds_read_b64 v[22:23], v95
  s_waitcnt lgkmcnt(5)
  v_mfma_f32_4x4x4_16b_bf16 v[8:11], v[4:5], v[24:25], v[8:11]
  ds_read_b64 v[24:25], v96
  s_waitcnt lgkmcnt(5)
  v_mfma_f32_4x4x4_16b_bf16 v[8:11], v[4:5], v[26:27], v[8:11]
  ds_read_b64 v[26:27], v97
  s_cmp_eq_u32 s21, 0
  s_cbranch_scc1 L_k3_45
  v_readfirstlane_b32 s37, v28
  s_cmp_ge_u32 s37, s18
  s_cbranch_scc0 L_k3_46
L_k3_47:
  v_add_u32 v28, s30, v1
  ds_read_b128 v[28:31], v28
L_k3_45:
  s_waitcnt lgkmcnt(5)
  v_mfma_f32_4x4x4_16b_bf16 v[8:11], v[4:5], v[16:17], v[8:11]
  ds_read_b64 v[16:17], v98
  s_waitcnt lgkmcnt(5)
  v_mfma_f32_4x4x4_16b_bf16 v[8:11], v[4:5], v[18:19], v[8:11]
  ds_read_b64 v[18:19], v99
  s_waitcnt lgkmcnt(5)
  v_mfma_f32_4x4x4_16b_bf16 v[8:11], v[4:5], v[20:21], v[8:11]
  ds_read_b64 v[20:21], v100
  s_waitcnt lgkmcnt(5)
  v_mfma_f32_4x4x4_16b_bf16 v[8:11], v[4:5], v[22:23], v[8:11]
  ds_read_b64 v[22:23], v101
  s_waitcnt lgkmcnt(5)
  v_mfma_f32_4x4x4_16b_bf16 v[12:15], v[4:5], v[24:25], v[12:15]
  ds_read_b64 v[24:25], v102
  s_waitcnt lgkmcnt(5)
  v_mfma_f32_4x4x4_16b_bf16 v[12:15], v[4:5], v[26:27], v[12:15]
  ds_read_b64 v[26:27], v103
  s_cmp_eq_u32 s21, 0
  s_cbranch_scc1 L_k3_48
  v_add_f32 v8, v8, v28
  v_add_f32 v9, v9, v29
  v_add_f32 v10, v10, v30
  v_add_f32 v11, v11, v31
  v_add_u32 v28, s30, v1
  ds_read_b128 v[28:31], v28 offset:1024
L_k3_48:
  s_waitcnt lgkmcnt(5)
  v_mfma_f32_4x4x4_16b_bf16 v[12:15], v[4:5], v[16:17], v[12:15]
  ds_read_b64 v[16:17], v104
  v_mul_f32 v8, v8, v2
  v_mul_f32 v9, v9, v2
  v_mul_f32 v10, v10, v2
  v_mul_f32 v11, v11, v2
  v_cvt_pk_bf16_f32 v6, v8, v9
  v_cvt_pk_bf16_f32 v7, v10, v11
  v_mul_f32 v8, v8, v2
  v_mul_f32 v9, v9, v2
  v_mul_f32 v10, v10, v2
  v_mul_f32 v11, v11, v2
  v_add_u32 v8, s17, v8
  v_add_u32 v10, s17, v10
  v_bfi_b32 v8, s31, v0, v8
  v_bfi_b32 v10, s31, v0, v10
  v_cvt_pk_bf16_f32 v8, v8, v9
  v_cvt_pk_bf16_f32 v9, v10, v11
  s_nop 1
  v_mov_b32_dpp v10, v9 quad_perm:[0,0,1,1] row_mask:0xf bank_mask:0xf
  v_mov_b32_dpp v11, v9 quad_perm:[2,2,3,3] row_mask:0xf bank_mask:0xf
  s_nop 0
  v_cndmask_b32_dpp v10, v8, v10, vcc quad_perm:[0,0,1,1] row_mask:0xf bank_mask:0xf
  v_cndmask_b32_dpp v11, v8, v11, vcc quad_perm:[2,2,3,3] row_mask:0xf bank_mask:0xf
  s_waitcnt lgkmcnt(5)
  v_mfma_f32_4x4x4_16b_bf16 v[12:15], v[4:5], v[18:19], v[12:15]
  ds_read_b64 v[18:19], v105
  s_setprio 0
  s_cmp_eq_u32 s20, 1
  s_cbranch_scc0 L_k3_49
  buffer_store_dwordx2 v[10:11], v1, s[12:15], s26 offen
L_k3_50:
  s_waitcnt lgkmcnt(5)
  v_mfma_f32_4x4x4_16b_bf16 v[12:15], v[4:5], v[20:21], v[12:15]
  ds_read_b64 v[20:21], v106
  v_mul_f32 v8, v3, v3
  s_waitcnt lgkmcnt(5)
  v_mfma_f32_4x4x4_16b_bf16 v[12:15], v[4:5], v[22:23], v[12:15]
  ds_read_b64 v[22:23], v107
  s_waitcnt lgkmcnt(5)
  v_mfma_f32_4x4x4_16b_bf16 v[12:15], v[4:5], v[24:25], v[12:15]
  ds_read_b64 v[24:25], v108
  s_waitcnt lgkmcnt(5)
  v_mfma_f32_4x4x4_16b_bf16 v[12:15], v[4:5], v[26:27], v[12:15]
  ds_read_b64 v[26:27], v109
  v_mov_b32 v9, 1
  v_mov_b32 v10, 125440
  s_waitcnt lgkmcnt(5)
  v_mfma_f32_4x4x4_16b_bf16 v[12:15], v[4:5], v[16:17], v[12:15]
  ds_read_b64 v[16:17], v110
  s_waitcnt lgkmcnt(5)
  v_mfma_f32_4x4x4_16b_bf16 v[12:15], v[4:5], v[18:19], v[12:15]
  ds_read_b64 v[18:19], v111
  s_waitcnt lgkmcnt(5)
  v_mfma_f32_4x4x4_16b_bf16 v[12:15], v[4:5], v[20:21], v[12:15]
  ds_read_b64 v[20:21], v112
  s_waitcnt lgkmcnt(5)
  v_mfma_f32_4x4x4_16b_bf16 v[12:15], v[4:5], v[22:23], v[12:15]
  ds_read_b64 v[22:23], v113
  s_waitcnt lgkmcnt(5)
  v_mfma_f32_4x4x4_16b_bf16 v[12:15], v[4:5], v[24:25], v[12:15]
  ds_read_b64 v[24:25], v114
  s_waitcnt lgkmcnt(5)
  v_mfma_f32_4x4x4_16b_bf16 v[12:15], v[4:5], v[26:27], v[12:15]
  ds_read_b64 v[26:27], v115
  s_waitcnt lgkmcnt(5)
  v_mfma_f32_4x4x4_16b_bf16 v[12:15], v[4:5], v[16:17], v[12:15]
  ds_read_b64 v[16:17], v116
  s_waitcnt lgkmcnt(5)
  v_mfma_f32_4x4x4_16b_bf16 v[12:15], v[4:5], v[18:19], v[12:15]
  ds_read_b64 v[18:19], v117
  s_waitcnt lgkmcnt(5)
  v_mfma_f32_4x4x4_16b_bf16 v[12:15], v[4:5], v[20:21], v[12:15]
  ds_read_b64 v[20:21], v118
  s_waitcnt lgkmcnt(5)
  v_mfma_f32_4x4x4_16b_bf16 v[12:15], v[4:5], v[22:23], v[12:15]
  ds_read_b64 v[22:23], v119
  s_waitcnt lgkmcnt(5)
  v_mfma_f32_4x4x4_16b_bf16 v[12:15], v[4:5], v[24:25], v[12:15]
  ds_read_b64 v[24:25], v120
  s_waitcnt lgkmcnt(5)
  v_mfma_f32_4x4x4_16b_bf16 v[12:15], v[4:5], v[26:27], v[12:15]
  ds_read_b64 v[26:27], v121
  s_waitcnt lgkmcnt(5)
  v_mfma_f32_4x4x4_16b_bf16 v[12:15], v[4:5], v[16:17], v[12:15]
  ds_read_b64 v[16:17], v122
  s_waitcnt lgkmcnt(5)
  v_mfma_f32_4x4x4_16b_bf16 v[12:15], v[4:5], v[18:19], v[12:15]
  ds_read_b64 v[18:19], v123
  s_waitcnt lgkmcnt(5)
  v_mfma_f32_4x4x4_16b_bf16 v[12:15], v[4:5], v[20:21], v[12:15]
  ds_read_b64 v[20:21], v124
  s_waitcnt lgkmcnt(5)
  v_mfma_f32_4x4x4_16b_bf16 v[12:15], v[4:5], v[22:23], v[12:15]
  ds_read_b64 v[22:23], v125
  s_waitcnt lgkmcnt(5)
  v_mfma_f32_4x4x4_16b_bf16 v[12:15], v[4:5], v[24:25], v[12:15]
  ds_read_b64 v[24:25], v126
  s_waitcnt lgkmcnt(5)
  v_mfma_f32_4x4x4_16b_bf16 v[12:15], v[4:5], v[26:27], v[12:15]
  ds_read_b64 v[26:27], v127
  s_mov_b64 exec, 1
  ds_add_u32 v10, v9 offset:12
  s_mov_b64 exec, -1
  s_waitcnt lgkmcnt(6)
  v_mfma_f32_4x4x4_16b_bf16 v[12:15], v[4:5], v[16:17], v[12:15]
  s_waitcnt lgkmcnt(5)
  s_nop 0
  v_mfma_f32_4x4x4_16b_bf16 v[12:15], v[4:5], v[18:19], v[12:15]
  s_waitcnt lgkmcnt(4)
  s_nop 0
  v_mfma_f32_4x4x4_16b_bf16 v[12:15], v[4:5], v[20:21], v[12:15]
  s_waitcnt lgkmcnt(3)
  s_nop 0
  v_mfma_f32_4x4x4_16b_bf16 v[12:15], v[4:5], v[22:23], v[12:15]
  s_waitcnt lgkmcnt(2)
  s_nop 0
  v_mfma_f32_4x4x4_16b_bf16 v[12:15], v[4:5], v[24:25], v[12:15]
  s_waitcnt lgkmcnt(1)
  s_nop 0
  v_mfma_f32_4x4x4_16b_bf16 v[12:15], v[4:5], v[26:27], v[12:15]
K3_TAIL2:
  s_setprio 3
  s_cmp_eq_u32 s21, 0
  s_cbranch_scc1 L_k3_51
  s_nop 1
  v_add_f32 v12, v12, v28
  v_add_f32 v13, v13, v29
  v_add_f32 v14, v14, v30
  v_add_f32 v15, v15, v31
L_k3_51:
  s_cmp_eq_u32 s18, 7
  s_cbranch_scc1 K3_LAST
  v_mul_f32 v16, v12, v8
  v_mul_f32 v17, v13, v8
  v_mul_f32 v18, v14, v8
  v_mul_f32 v19, v15, v8
  v_add_u32 v16, s17, v16
  v_add_u32 v18, s17, v18
  v_bfi_b32 v16, s31, v0, v16
  v_bfi_b32 v18, s31, v0, v18
  v_cvt_pk_bf16_f32 v16, v16, v17
  v_cvt_pk_bf16_f32 v17, v18, v19
  s_nop 1
  v_mov_b32_dpp v10, v17 quad_perm:[0,0,1,1] row_mask:0xf bank_mask:0xf
  v_mov_b32_dpp v11, v17 quad_perm:[2,2,3,3] row_mask:0xf bank_mask:0xf
  s_nop 0
  v_cndmask_b32_dpp v10, v16, v10, vcc quad_perm:[0,0,1,1] row_mask:0xf bank_mask:0xf
  v_cndmask_b32_dpp v11, v16, v11, vcc quad_perm:[2,2,3,3] row_mask:0xf bank_mask:0xf
  s_cmp_eq_u32 s20, 1
  s_cbranch_scc0 L_k3_52
  buffer_store_dwordx2 v[10:11], v1, s[12:15], s27 offen
L_k3_53:
  v_mul_f32 v12, v12, v3
  v_mul_f32 v13, v13, v3
  v_mul_f32 v14, v14, v3
  v_mul_f32 v15, v15, v3
  v_cvt_pk_bf16_f32 v30, v12, v13
  v_cvt_pk_bf16_f32 v31, v14, v15
  v_mov_b64 v[28:29], v[6:7]
  s_add_u32 s18, s18, 1
  s_add_u32 s46, s46, 16
  s_add_u32 s38, s38, 4
  s_xor_b64 s[12:13], s[12:13], s[24:25]
  s_bfe_i32 s16, s18, 0x10001
  s_andn2_b32 s17, 0x10000, s16
  v_lshlrev_b32 v0, 16, s16
  s_cmp_eq_u32 s18, 7
  s_cselect_b32 s20, 0, s20
  s_mov_b64 vcc, s[32:33]
  s_barrier
  s_branch K3_LOOP2
L_k3_42:
  v_mov_b32 v6, 125440
  ds_read_b32 v6, v6 offset:16
  s_waitcnt lgkmcnt(0)
  v_readfirstlane_b32 s37, v6
  s_cmp_ge_u32 s37, s38
  s_cbranch_scc1 L_k3_43
  s_sleep 1
  s_sub_u32 s19, s19, 1
  s_cbranch_scc0 L_k3_42
  s_mov_b32 s19, 0
  s_branch L_k3_43
L_k3_46:
  v_mov_b32 v28, 125440
  ds_read_b32 v28, v28 offset:8
  s_waitcnt lgkmcnt(0)
  v_readfirstlane_b32 s37, v28
  s_cmp_ge_u32 s37, s18
  s_cbranch_scc1 L_k3_47
  s_sleep 1
  s_sub_u32 s19, s19, 1
  s_cbranch_scc0 L_k3_46
  s_mov_b32 s19, 0
  s_branch L_k3_47
L_k3_49:
  s_cmp_eq_u32 s20, 2
  s_cbranch_scc0 L_k3_50
  buffer_store_dwordx2 v[10:11], v1, s[12:15], s26 offen sc1
  s_branch L_k3_50
L_k3_52:
  s_cmp_eq_u32 s20, 2
  s_cbranch_scc0 L_k3_53
  buffer_store_dwordx2 v[10:11], v1, s[12:15], s27 offen sc1
  s_branch L_k3_53
K3_LAST:
  v_mul_f32 v12, v12, v3
  v_mul_f32 v13, v13, v3
  v_mul_f32 v14, v14, v3
  v_mul_f32 v15, v15, v3
  v_cvt_pk_bf16_f32 v8, v12, v13
  v_cvt_pk_bf16_f32 v9, v14, v15
  buffer_store_dwordx4 v[6:9], v1, s[8:11], s22 offen sc1
K3_END:
  s_endpgm
K3_AUX:
  s_setprio 3
  v_mov_b32 v31, 0
  s_mul_i32 s7, s4, 6272
  s_add_u32 s7, s7, 9592832
  s_cmp_lg_u32 s3, 12
  s_cbranch_scc1 K3_P13
  buffer_load_dwordx4 v[92:95], v1, s[8:11], s7 offen offset:0
  buffer_load_dwordx4 v[100:103], v1, s[8:11], s7 offen offset:1024
  buffer_load_dwordx4 v[108:111], v1, s[8:11], s7 offen offset:2048
  buffer_load_dwordx4 v[116:119], v1, s[8:11], s7 offen offset:3072
  s_add_u32 s7, s7, 6144
  buffer_load_dword v30, v0, s[8:11], s7 offen
  s_lshl_b32 s7, s4, 6
  s_add_u32 s7, s7, 24576
  v_bfe_u32 v2, v1, 3, 6
  v_add_u32 v2, s7, v2
  buffer_load_short_d16_hi v8, v2, s[40:43], 0 offen
  v_lshlrev_b32 v31, 2, v2
  v_bfe_u32 v6, v2, 1, 1
  v_mul_u32_u24 v6, 50176, v6
  v_lshlrev_b32 v7, 1, v2
  s_movk_i32 s7, 0xf0
  v_bfi_b32 v7, s7, v2, v7
  v_lshlrev_b32 v2, 5, v2
  s_movk_i32 s7, 0x100
  v_bfi_b32 v7, s7, v2, v7
  v_and_b32 v7, -8, v7
  v_add_u32 v2, v6, v7
  s_waitcnt vmcnt(6)
  s_branch K3_PC
K3_P13:
  s_cmp_lg_u32 s3, 13
  s_cbranch_scc1 K3_P14
  v_mov_b32 v32, 0
  v_mov_b32 v33, 0
  v_mov_b32 v34, 0
  v_mov_b32 v35, 0
  v_mov_b32 v36, 0
  v_mov_b32 v37, 0
  v_mov_b32 v38, 0
  v_mov_b32 v39, 0
  v_mov_b32 v3, 0
  v_mov_b32 v116, 0
  v_mov_b32 v117, 0
  v_mov_b32 v118, 0
  v_mov_b32 v119, 0
  s_sub_u32 s7, s7, s6
  s_add_u32 s6, s6, 6144
  v_lshrrev_b32 v2, 5, v1
  v_mul_u32_u24 v2, 6272, v2
  v_mov_b32 v7, s7
  v_cmp_le_u32 vcc, 768, v1
  s_nop 1
  v_cndmask_b32 v2, v2, v7, vcc
  v_and_b32 v6, 16, v1
  v_lshl_add_u32 v2, v6, 1, v2
  s_mov_b32 exec_hi, 0x3ffff
  buffer_load_dwordx4 v[32:35], v2, s[8:11], s6 offen offset:64
  buffer_load_dwordx4 v[36:39], v2, s[8:11], s6 offen offset:80
  s_mov_b32 exec_hi, 0x1ffff
  s_mov_b32 s37, 262144
  buffer_load_dwordx4 v[116:119], v1, s[8:11], s37 offen
  v_lshrrev_b32 v2, 4, v1
  v_mul_u32_u24 v2, 6272, v2
  v_cmp_le_u32 vcc, 384, v1
  s_nop 1
  v_cndmask_b32 v2, v2, v7, vcc
  s_mov_b64 exec, 0x1ffffff
  buffer_load_dword v3, v2, s[8:11], s6 offen
  s_mov_b64 exec, -1
  v_mov_b32 v12, 0x7fff8
  v_mov_b32 v13, v12
  v_mov_b32 v14, v12
  v_mov_b32 v15, v12
  v_add_u32 v2, 133184, v1
  ds_write_b128 v2, v[12:15]
  ds_write_b128 v2, v[12:15] offset:1024
  ds_write_b128 v2, v[12:15] offset:2048
  ds_write_b128 v2, v[12:15] offset:3072
  s_waitcnt vmcnt(4)
  s_branch K3_PC
K3_P14:
  s_waitcnt vmcnt(0)
K3_PC:
  s_barrier
  s_add_u32 s24, s8, s13
  s_addc_u32 s25, s9, 0
  s_add_u32 s12, s24, 3211264
  s_addc_u32 s13, s25, 0
  s_xor_b64 s[24:25], s[24:25], s[12:13]
  s_add_u32 s22, s22, 67108864
  s_sub_u32 s7, s3, 12
  s_mul_i32 s26, s7, 12288
  s_mov_b32 m0, s26
  s_add_u32 s27, s26, 4096
  s_add_u32 s28, s26, 8192
  v_lshlrev_b32 v83, 6, v1
  v_add_u32 v83, 1008, v83
  s_lshr_b32 s29, s7, 1
  s_mul_i32 s29, s29, 50176
  s_and_b32 s7, s7, 1
  s_lshl_b32 s7, s7, 9
  s_add_u32 s7, s7, s29
  s_add_u32 s7, s7, 49152
  v_lshrrev_b32 v82, 1, v1
  v_add_u32 v82, s7, v82
  s_cmp_eq_u32 s3, 12
  s_cbranch_scc1 K3_F12
  s_cmp_eq_u32 s3, 13
  s_cbranch_scc1 K3_F13
  s_cmp_eq_u32 s3, 15
  s_cbranch_scc1 K3_MOVE
  s_mov_b64 exec, 1
K3_HS:
  v_mov_b32 v13, 0
  buffer_atomic_add v13, v1, s[8:11], s49 offen sc0 sc1
  s_waitcnt vmcnt(0)
  v_readfirstlane_b32 s48, v13
  s_and_b32 s20, s48, 0xfff8
  s_cbranch_scc1 K3_HS2
  s_sleep 2
  s_sub_u32 s19, s19, 1
  s_cbranch_scc0 K3_HS
  s_mov_b32 s19, 0
  s_mov_b32 s48, -1
K3_HS2:
  s_cmp_lt_u32 s48, 0x10000
  s_cselect_b32 s20, 1, 2
  v_mov_b32 v12, 125440
  v_mov_b32 v13, s20
  ds_write_b32 v12, v13
  s_mov_b64 exec, -1
  s_branch K3_MOVE
K3_F13:
  s_mov_b32 s48, 0
  s_mov_b32 s39, 100352
  s_waitcnt vmcnt(2)
  v_cmp_gt_i32 vcc, 0, v32
  s_cbranch_vccz K3_F13B
  v_mov_b32 v12, s48
  v_mbcnt_lo_u32_b32 v12, vcc_lo, v12
  v_mbcnt_hi_u32_b32 v12, vcc_hi, v12
  v_lshlrev_b32 v12, 2, v12
  v_add_u32 v12, 125504, v12
  s_bcnt1_i32_b64 s37, vcc
  s_add_u32 s48, s48, s37
  s_mov_b64 exec, vcc
  ds_write_b32 v12, v32
  s_mov_b64 exec, -1
  v_cmp_gt_i32 vcc, 0, v33
  s_cbranch_vccz K3_F13B
  v_mov_b32 v12, s48
  v_mbcnt_lo_u32_b32 v12, vcc_lo, v12
  v_mbcnt_hi_u32_b32 v12, vcc_hi, v12
  v_lshlrev_b32 v12, 2, v12
  v_add_u32 v12, 125504, v12
  s_bcnt1_i32_b64 s37, vcc
  s_add_u32 s48, s48, s37
  s_mov_b64 exec, vcc
  ds_write_b32 v12, v33
  s_mov_b64 exec, -1
  v_cmp_gt_i32 vcc, 0, v34
  s_cbranch_vccz K3_F13B
  v_mov_b32 v12, s48
  v_mbcnt_lo_u32_b32 v12, vcc_lo, v12
  v_mbcnt_hi_u32_b32 v12, vcc_hi, v12
  v_lshlrev_b32 v12, 2, v12
  v_add_u32 v12, 125504, v12
  s_bcnt1_i32_b64 s37, vcc
  s_add_u32 s48, s48, s37
  s_mov_b64 exec, vcc
  ds_write_b32 v12, v34
  s_mov_b64 exec, -1
  v_cmp_gt_i32 vcc, 0, v35
  s_cbranch_vccz K3_F13B
  v_mov_b32 v12, s48
  v_mbcnt_lo_u32_b32 v12, vcc_lo, v12
  v_mbcnt_hi_u32_b32 v12, vcc_hi, v12
  v_lshlrev_b32 v12, 2, v12
  v_add_u32 v12, 125504, v12
  s_bcnt1_i32_b64 s37, vcc
  s_add_u32 s48, s48, s37
  s_mov_b64 exec, vcc
  ds_write_b32 v12, v35
  s_mov_b64 exec, -1
  v_cmp_gt_i32 vcc, 0, v36
  s_cbranch_vccz K3_F13B
  v_mov_b32 v12, s48
  v_mbcnt_lo_u32_b32 v12, vcc_lo, v12
  v_mbcnt_hi_u32_b32 v12, vcc_hi, v12
  v_lshlrev_b32 v12, 2, v12
  v_add_u32 v12, 125504, v12
  s_bcnt1_i32_b64 s37, vcc
  s_add_u32 s48, s48, s37
  s_mov_b64 exec, vcc
  ds_write_b32 v12, v36
  s_mov_b64 exec, -1
  v_cmp_gt_i32 vcc, 0, v37
  s_cbranch_vccz K3_F13B
  v_mov_b32 v12, s48
  v_mbcnt_lo_u32_b32 v12, vcc_lo, v12
  v_mbcnt_hi_u32_b32 v12, vcc_hi, v12
  v_lshlrev_b32 v12, 2, v12
  v_add_u32 v12, 125504, v12
  s_bcnt1_i32_b64 s37, vcc
  s_add_u32 s48, s48, s37
  s_mov_b64 exec, vcc
  ds_write_b32 v12, v37
  s_mov_b64 exec, -1
  v_cmp_gt_i32 vcc, 0, v38
  s_cbranch_vccz K3_F13B
  v_mov_b32 v12, s48
  v_mbcnt_lo_u32_b32 v12, vcc_lo, v12
  v_mbcnt_hi_u32_b32 v12, vcc_hi, v12
  v_lshlrev_b32 v12, 2, v12
  v_add_u32 v12, 125504, v12
  s_bcnt1_i32_b64 s37, vcc
  s_add_u32 s48, s48, s37
  s_mov_b64 exec, vcc
  ds_write_b32 v12, v38
  s_mov_b64 exec, -1
  v_cmp_gt_i32 vcc, 0, v39
  s_cbranch_vccz K3_F13B
  v_mov_b32 v12, s48
  v_mbcnt_lo_u32_b32 v12, vcc_lo, v12
  v_mbcnt_hi_u32_b32 v12, vcc_hi, v12
  v_lshlrev_b32 v12, 2, v12
  v_add_u32 v12, 125504, v12
  s_bcnt1_i32_b64 s37, vcc
  s_add_u32 s48, s48, s37
  s_mov_b64 exec, vcc
  ds_write_b32 v12, v39
  s_mov_b64 exec, -1
K3_F13B:
  v_lshrrev_b32 v12, 2, v1
  v_add_u32 v12, 125504, v12
  ds_read_b32 v14, v12
  s_waitcnt vmcnt(0)
  v_or3_b32 v12, v116, v117, v118
  v_or_b32 v12, v12, v119
  v_cmp_ne_u32 vcc, 0, v12
  v_cmp_lt_u32 s[50:51], 16, v3
  s_or_b64 vcc, vcc, s[50:51]
  s_cselect_b32 s21, 2, 1
  s_cmp_gt_u32 s48, 64
  s_cselect_b32 s21, 2, s21
  v_mov_b32 v12, 125440
  v_mov_b32 v13, s21
  ds_write_b32 v12, v13 offset:4
  s_cmp_eq_u32 s21, 2
  s_cbranch_scc1 K3_SLOW
  s_cmp_eq_u32 s48, 0
  s_cbranch_scc1 K3_MOVE
  s_waitcnt lgkmcnt(1)
  v_cmpx_gt_i32 vcc, 0, v14
  v_bfe_u32 v31, v14, 16, 11
  v_lshl_add_u32 v31, v31, 4, s39
  v_mov_b32 v13, 1
  ds_add_rtn_u32 v13, v31, v13
  v_lshlrev_b32 v15, 2, v1
  v_add_u32 v15, 133184, v15
  v_lshlrev_b32_sdwa v14, 3, v14 dst_sel:DWORD dst_unused:UNUSED_PAD src0_sel:DWORD src1_sel:WORD_0
  s_mov_b64 s[52:53], exec
  s_waitcnt lgkmcnt(0)
  v_cmp_le_u32 vcc, 4, v13
  s_cmp_lg_u64 vcc, 0
  s_cselect_b32 s48, 2, 1
  v_cmp_le_u32 vcc, 8, v13
  s_cmp_lg_u64 vcc, 0
  s_cselect_b32 s48, 3, s48
  v_cmp_le_u32 vcc, 12, v13
  s_cmp_lg_u64 vcc, 0
  s_cselect_b32 s48, 4, s48
  v_cmpx_eq_u32 vcc, 0, v13
  s_mov_b64 s[50:51], exec
  ds_write_b32 v31, v15 offset:4
  s_mov_b64 exec, s[52:53]
  ds_read_b32 v12, v31 offset:4
  s_waitcnt lgkmcnt(0)
  v_lshl_add_u32 v12, v13, 2, v12
  ds_write_b32 v12, v14
  ds_read_b128 v[88:91], v15 offset:0
  ds_read_b128 v[92:95], v15 offset:16
  ds_read_b128 v[96:99], v15 offset:32
  ds_read_b128 v[100:103], v15 offset:48
  s_mov_b64 exec, -1
  s_waitcnt lgkmcnt(0)
  s_branch K3_H13F
K3_F12:
  s_waitcnt vmcnt(0)
  v_cmp_ne_u32 vcc, 0, v30
  s_mov_b32 s21, vcc_lo
  v_mov_b32 v3, v8
  v_lshlrev_b32_sdwa v88, 3, v92 dst_sel:DWORD dst_unused:UNUSED_PAD src0_sel:DWORD src1_sel:WORD_0
  v_lshlrev_b32_sdwa v89, 3, v92 dst_sel:DWORD dst_unused:UNUSED_PAD src0_sel:DWORD src1_sel:WORD_1
  v_lshlrev_b32_sdwa v90, 3, v93 dst_sel:DWORD dst_unused:UNUSED_PAD src0_sel:DWORD src1_sel:WORD_0
  v_lshlrev_b32_sdwa v91, 3, v93 dst_sel:DWORD dst_unused:UNUSED_PAD src0_sel:DWORD src1_sel:WORD_1
  v_lshlrev_b32_sdwa v92, 3, v94 dst_sel:DWORD dst_unused:UNUSED_PAD src0_sel:DWORD src1_sel:WORD_0
  v_lshlrev_b32_sdwa v93, 3, v94 dst_sel:DWORD dst_unused:UNUSED_PAD src0_sel:DWORD src1_sel:WORD_1
  v_lshlrev_b32_sdwa v94, 3, v95 dst_sel:DWORD dst_unused:UNUSED_PAD src0_sel:DWORD src1_sel:WORD_0
  v_lshlrev_b32_sdwa v95, 3, v95 dst_sel:DWORD dst_unused:UNUSED_PAD src0_sel:DWORD src1_sel:WORD_1
  v_lshlrev_b32_sdwa v96, 3, v100 dst_sel:DWORD dst_unused:UNUSED_PAD src0_sel:DWORD src1_sel:WORD_0
  v_lshlrev_b32_sdwa v97, 3, v100 dst_sel:DWORD dst_unused:UNUSED_PAD src0_sel:DWORD src1_sel:WORD_1
  v_lshlrev_b32_sdwa v98, 3, v101 dst_sel:DWORD dst_unused:UNUSED_PAD src0_sel:DWORD src1_sel:WORD_0
  v_lshlrev_b32_sdwa v99, 3, v101 dst_sel:DWORD dst_unused:UNUSED_PAD src0_sel:DWORD src1_sel:WORD_1
  v_lshlrev_b32_sdwa v100, 3, v102 dst_sel:DWORD dst_unused:UNUSED_PAD src0_sel:DWORD src1_sel:WORD_0
  v_lshlrev_b32_sdwa v101, 3, v102 dst_sel:DWORD dst_unused:UNUSED_PAD src0_sel:DWORD src1_sel:WORD_1
  v_lshlrev_b32_sdwa v102, 3, v103 dst_sel:DWORD dst_unused:UNUSED_PAD src0_sel:DWORD src1_sel:WORD_0
  v_lshlrev_b32_sdwa v103, 3, v103 dst_sel:DWORD dst_unused:UNUSED_PAD src0_sel:DWORD src1_sel:WORD_1
  v_lshlrev_b32_sdwa v104, 3, v108 dst_sel:DWORD dst_unused:UNUSED_PAD src0_sel:DWORD src1_sel:WORD_0
  v_lshlrev_b32_sdwa v105, 3, v108 dst_sel:DWORD dst_unused:UNUSED_PAD src0_sel:DWORD src1_sel:WORD_1
  v_lshlrev_b32_sdwa v106, 3, v109 dst_sel:DWORD dst_unused:UNUSED_PAD src0_sel:DWORD src1_sel:WORD_0
  v_lshlrev_b32_sdwa v107, 3, v109 dst_sel:DWORD dst_unused:UNUSED_PAD src0_sel:DWORD src1_sel:WORD_1
  v_lshlrev_b32_sdwa v108, 3, v110 dst_sel:DWORD dst_unused:UNUSED_PAD src0_sel:DWORD src1_sel:WORD_0
  v_lshlrev_b32_sdwa v109, 3, v110 dst_sel:DWORD dst_unused:UNUSED_PAD src0_sel:DWORD src1_sel:WORD_1
  v_lshlrev_b32_sdwa v110, 3, v111 dst_sel:DWORD dst_unused:UNUSED_PAD src0_sel:DWORD src1_sel:WORD_0
  v_lshlrev_b32_sdwa v111, 3, v111 dst_sel:DWORD dst_unused:UNUSED_PAD src0_sel:DWORD src1_sel:WORD_1
  v_lshlrev_b32_sdwa v112, 3, v116 dst_sel:DWORD dst_unused:UNUSED_PAD src0_sel:DWORD src1_sel:WORD_0
  v_lshlrev_b32_sdwa v113, 3, v116 dst_sel:DWORD dst_unused:UNUSED_PAD src0_sel:DWORD src1_sel:WORD_1
  v_lshlrev_b32_sdwa v114, 3, v117 dst_sel:DWORD dst_unused:UNUSED_PAD src0_sel:DWORD src1_sel:WORD_0
  v_lshlrev_b32_sdwa v115, 3, v117 dst_sel:DWORD dst_unused:UNUSED_PAD src0_sel:DWORD src1_sel:WORD_1
  v_lshlrev_b32_sdwa v116, 3, v118 dst_sel:DWORD dst_unused:UNUSED_PAD src0_sel:DWORD src1_sel:WORD_0
  v_lshlrev_b32_sdwa v117, 3, v118 dst_sel:DWORD dst_unused:UNUSED_PAD src0_sel:DWORD src1_sel:WORD_1
  v_lshlrev_b32_sdwa v118, 3, v119 dst_sel:DWORD dst_unused:UNUSED_PAD src0_sel:DWORD src1_sel:WORD_0
  v_lshlrev_b32_sdwa v119, 3, v119 dst_sel:DWORD dst_unused:UNUSED_PAD src0_sel:DWORD src1_sel:WORD_1
  v_mov_b32 v14, 125440
L_k3_54:
  ds_read_b64 v[12:13], v14
  s_waitcnt lgkmcnt(0)
  v_readfirstlane_b32 s20, v12
  v_readfirstlane_b32 s37, v13
  s_mul_i32 s47, s20, s37
  s_cmp_lg_u32 s47, 0
  s_cbranch_scc1 L_k3_55
  s_sleep 1
  s_sub_u32 s19, s19, 1
  s_cbranch_scc0 L_k3_54
  s_mov_b32 s19, 0
L_k3_55:
  s_and_b32 s37, s37, 2
  s_or_b32 s21, s21, s37
  s_branch K3_H12
K3_ALOOP:
  s_cmp_ge_u32 s3, 14
  s_cbranch_scc1 K3_MOVE
K3_AP:
  v_mov_b32 v12, 125440
  ds_read_b32 v12, v12 offset:16
  s_waitcnt lgkmcnt(0)
  v_readfirstlane_b32 s37, v12
  s_cmp_ge_u32 s37, s38
  s_cbranch_scc1 K3_AQ
  s_sleep 1
  s_sub_u32 s19, s19, 1
  s_cbranch_scc0 K3_AP
  s_mov_b32 s19, 0
  s_branch K3_AQ
K3_AQ:
  s_cmp_eq_u32 s3, 12
  s_cbranch_scc1 K3_H12
  s_cmp_eq_u32 s21, 2
  s_cbranch_scc1 K3_SLOW
  s_cmp_eq_u32 s48, 0
  s_cbranch_scc1 K3_MOVE
K3_H13F:
  s_mov_b64 exec, s[50:51]
  ds_read_b64 v[32:33], v88
  ds_read_b64 v[34:35], v89
  ds_read_b64 v[36:37], v90
  ds_read_b64 v[38:39], v91
  s_cmp_eq_u32 s48, 1
  s_cbranch_scc1 K3_H13W
  ds_read_b64 v[40:41], v92
  ds_read_b64 v[42:43], v93
  ds_read_b64 v[44:45], v94
  ds_read_b64 v[46:47], v95
  s_cmp_eq_u32 s48, 2
  s_cbranch_scc1 K3_H13W
  ds_read_b64 v[48:49], v96
  ds_read_b64 v[50:51], v97
  ds_read_b64 v[52:53], v98
  ds_read_b64 v[54:55], v99
  s_cmp_eq_u32 s48, 3
  s_cbranch_scc1 K3_H13W
  ds_read_b64 v[56:57], v100
  ds_read_b64 v[58:59], v101
  ds_read_b64 v[60:61], v102
  ds_read_b64 v[62:63], v103
K3_H13W:
  s_mov_b64 exec, -1
  s_waitcnt lgkmcnt(0)
  v_mfma_f32_4x4x4_16b_bf16 v[8:11], v[4:5], v[32:33], 0
  s_nop 1
  v_mfma_f32_4x4x4_16b_bf16 v[8:11], v[4:5], v[34:35], v[8:11]
  s_nop 1
  v_mfma_f32_4x4x4_16b_bf16 v[8:11], v[4:5], v[36:37], v[8:11]
  s_nop 1
  v_mfma_f32_4x4x4_16b_bf16 v[8:11], v[4:5], v[38:39], v[8:11]
  s_cmp_eq_u32 s48, 1
  s_cbranch_scc1 K3_H13G
  v_mfma_f32_4x4x4_16b_bf16 v[8:11], v[4:5], v[40:41], v[8:11]
  s_nop 1
  v_mfma_f32_4x4x4_16b_bf16 v[8:11], v[4:5], v[42:43], v[8:11]
  s_nop 1
  v_mfma_f32_4x4x4_16b_bf16 v[8:11], v[4:5], v[44:45], v[8:11]
  s_nop 1
  v_mfma_f32_4x4x4_16b_bf16 v[8:11], v[4:5], v[46:47], v[8:11]
  s_cmp_eq_u32 s48, 2
  s_cbranch_scc1 K3_H13G
  v_mfma_f32_4x4x4_16b_bf16 v[8:11], v[4:5], v[48:49], v[8:11]
  s_nop 1
  v_mfma_f32_4x4x4_16b_bf16 v[8:11], v[4:5], v[50:51], v[8:11]
  s_nop 1
  v_mfma_f32_4x4x4_16b_bf16 v[8:11], v[4:5], v[52:53], v[8:11]
  s_nop 1
  v_mfma_f32_4x4x4_16b_bf16 v[8:11], v[4:5], v[54:55], v[8:11]
  s_cmp_eq_u32 s48, 3
  s_cbranch_scc1 K3_H13G
  v_mfma_f32_4x4x4_16b_bf16 v[8:11], v[4:5], v[56:57], v[8:11]
  s_nop 1
  v_mfma_f32_4x4x4_16b_bf16 v[8:11], v[4:5], v[58:59], v[8:11]
  s_nop 1
  v_mfma_f32_4x4x4_16b_bf16 v[8:11], v[4:5], v[60:61], v[8:11]
  s_nop 1
  v_mfma_f32_4x4x4_16b_bf16 v[8:11], v[4:5], v[62:63], v[8:11]
K3_H13G:
  s_mov_b64 exec, s[50:51]
  s_nop 4
  ds_write_b128 v31, v[8:11]
  s_mov_b64 exec, -1
  s_branch K3_H13D
K3_SLOW:
  v_add_u32 v12, 100352, v1
  v_mov_b64 v[8:9], 0
  v_mov_b64 v[10:11], 0
  ds_write_b128 v12, v[8:11] offset:0
  ds_write_b128 v12, v[8:11] offset:1024
  ds_write_b128 v12, v[8:11] offset:2048
  ds_write_b128 v12, v[8:11] offset:3072
  ds_write_b128 v12, v[8:11] offset:4096
  ds_write_b128 v12, v[8:11] offset:5120
  ds_write_b128 v12, v[8:11] offset:6144
  ds_write_b128 v12, v[8:11] offset:7168
  ds_write_b128 v12, v[8:11] offset:8192
  ds_write_b128 v12, v[8:11] offset:9216
  ds_write_b128 v12, v[8:11] offset:10240
  ds_write_b128 v12, v[8:11] offset:11264
  ds_write_b128 v12, v[8:11] offset:12288
  ds_write_b128 v12, v[8:11] offset:13312
  ds_write_b128 v12, v[8:11] offset:14336
  ds_write_b128 v12, v[8:11] offset:15360
  ds_write_b128 v12, v[8:11] offset:16384
  ds_write_b128 v12, v[8:11] offset:17408
  ds_write_b128 v12, v[8:11] offset:18432
  ds_write_b128 v12, v[8:11] offset:19456
  ds_write_b128 v12, v[8:11] offset:20480
  ds_write_b128 v12, v[8:11] offset:21504
  ds_write_b128 v12, v[8:11] offset:22528
  ds_write_b128 v12, v[8:11] offset:23552
  ds_write_b128 v12, v[8:11] offset:24064
  s_mov_b32 s49, 0
K3_S1:
  v_readlane_b32 s50, v3, s49
  s_mul_i32 s51, s4, 24
  s_add_u32 s51, s51, s49
  s_add_u32 s52, s4, 192
  s_cmp_eq_u32 s49, 24
  s_cselect_b32 s51, s52, s51
  s_mul_i32 s51, s51, 25088
  s_add_u32 s51, s51, 10485760
  v_lshrrev_b32 v12, 4, v1
K3_S2:
  v_cmpx_gt_u32 vcc, s50, v12
  s_cbranch_execz K3_S3
  v_lshlrev_b32 v13, 2, v12
  buffer_load_dword v13, v13, s[8:11], s51 offen
  s_waitcnt vmcnt(0)
  v_bfe_u32 v18, v13, 16, 11
  v_lshl_add_u32 v18, v18, 4, s39
  v_lshlrev_b32_sdwa v16, 3, v13 dst_sel:DWORD dst_unused:UNUSED_PAD src0_sel:DWORD src1_sel:WORD_0
  ds_read_b64 v[14:15], v16
  s_waitcnt lgkmcnt(0)
  v_lshlrev_b32 v16, 16, v14
  v_and_b32 v14, 0xffff0000, v14
  v_lshlrev_b32 v17, 16, v15
  v_and_b32 v15, 0xffff0000, v15
  ds_add_f32 v18, v16
  ds_add_f32 v18, v14 offset:4
  ds_add_f32 v18, v17 offset:8
  ds_add_f32 v18, v15 offset:12
  v_add_u32 v12, 64, v12
  s_branch K3_S2
K3_S3:
  s_mov_b64 exec, -1
  s_add_u32 s49, s49, 1
  s_cmp_lt_u32 s49, 25
  s_cbranch_scc1 K3_S1
  s_mov_b32 s49, 0
  s_mul_i32 s44, s4, 1536
  s_add_u32 s45, s4, 192
K3_S4:
  s_lshr_b32 s51, s49, 2
  v_readlane_b32 s52, v116, s51
  v_readlane_b32 s53, v117, s51
  v_readlane_b32 s54, v118, s51
  v_readlane_b32 s55, v119, s51
  s_bitcmp1_b32 s49, 0
  s_cselect_b32 s52, s53, s52
  s_cselect_b32 s54, s55, s54
  s_bitcmp1_b32 s49, 1
  s_cselect_b32 s50, s54, s52
  s_lshl_b32 s51, s49, 13
  s_add_u32 s51, s51, 6291456
  v_lshrrev_b32 v12, 4, v1
K3_S5:
  v_cmpx_gt_u32 vcc, s50, v12
  s_cbranch_execz K3_S6
  v_lshlrev_b32 v13, 2, v12
  buffer_load_dword v13, v13, s[8:11], s51 offen
  s_mov_b64 s[52:53], exec
  s_waitcnt vmcnt(0)
  v_bfe_u32 v18, v13, 16, 14
  v_subrev_u32 v18, s44, v18
  v_cmp_gt_u32 vcc, 1536, v18
  s_nop 1
  v_cndmask_b32 v18, -1, v18, vcc
  v_bfe_u32 v14, v13, 22, 8
  v_bfe_u32 v15, v13, 16, 5
  v_add_u32 v15, 1536, v15
  v_cmp_eq_u32 vcc, s45, v14
  s_nop 1
  v_cndmask_b32 v18, v18, v15, vcc
  v_cmpx_le_i32 vcc, 0, v18
  s_cbranch_execz K3_S5B
  v_lshl_add_u32 v18, v18, 4, s39
  v_lshlrev_b32_sdwa v16, 3, v13 dst_sel:DWORD dst_unused:UNUSED_PAD src0_sel:DWORD src1_sel:WORD_0
  ds_read_b64 v[14:15], v16
  s_waitcnt lgkmcnt(0)
  v_lshlrev_b32 v16, 16, v14
  v_and_b32 v14, 0xffff0000, v14
  v_lshlrev_b32 v17, 16, v15
  v_and_b32 v15, 0xffff0000, v15
  ds_add_f32 v18, v16
  ds_add_f32 v18, v14 offset:4
  ds_add_f32 v18, v17 offset:8
  ds_add_f32 v18, v15 offset:12
K3_S5B:
  s_mov_b64 exec, s[52:53]
  v_add_u32 v12, 64, v12
  s_branch K3_S5
K3_S6:
  s_mov_b64 exec, -1
  s_add_u32 s49, s49, 1
  s_cmp_lt_u32 s49, 196
  s_cbranch_scc1 K3_S4
K3_H13D:
  v_mov_b32 v12, 125440
  v_mov_b32 v13, s18
  ds_write_b32 v12, v13 offset:8
  s_branch K3_MOVE
K3_H12:
  s_setprio 3
  ds_read_b64 v[16:17], v88
  ds_read_b64 v[18:19], v89
  ds_read_b64 v[20:21], v90
  ds_read_b64 v[22:23], v91
  ds_read_b64 v[24:25], v92
  ds_read_b64 v[26:27], v93
  s_waitcnt lgkmcnt(5)
  v_mfma_f32_4x4x4_16b_bf16 v[8:11], v[4:5], v[16:17], 0
  ds_read_b64 v[16:17], v94
  s_waitcnt lgkmcnt(5)
  v_mfma_f32_4x4x4_16b_bf16 v[8:11], v[4:5], v[18:19], v[8:11]
  ds_read_b64 v[18:19], v95
  s_waitcnt lgkmcnt(5)
  v_mfma_f32_4x4x4_16b_bf16 v[8:11], v[4:5], v[20:21], v[8:11]
  ds_read_b64 v[20:21], v96
  s_waitcnt lgkmcnt(5)
  v_mfma_f32_4x4x4_16b_bf16 v[8:11], v[4:5], v[22:23], v[8:11]
  ds_read_b64 v[22:23], v97
  s_waitcnt lgkmcnt(5)
  v_mfma_f32_4x4x4_16b_bf16 v[8:11], v[4:5], v[24:25], v[8:11]
  ds_read_b64 v[24:25], v98
  s_waitcnt lgkmcnt(5)
  v_mfma_f32_4x4x4_16b_bf16 v[8:11], v[4:5], v[26:27], v[8:11]
  ds_read_b64 v[26:27], v99
  s_waitcnt lgkmcnt(5)
  v_mfma_f32_4x4x4_16b_bf16 v[8:11], v[4:5], v[16:17], v[8:11]
  ds_read_b64 v[16:17], v100
  s_waitcnt lgkmcnt(5)
  v_mfma_f32_4x4x4_16b_bf16 v[8:11], v[4:5], v[18:19], v[8:11]
  ds_read_b64 v[18:19], v101
  s_waitcnt lgkmcnt(5)
  v_mfma_f32_4x4x4_16b_bf16 v[8:11], v[4:5], v[20:21], v[8:11]
  ds_read_b64 v[20:21], v102
  s_waitcnt lgkmcnt(5)
  v_mfma_f32_4x4x4_16b_bf16 v[8:11], v[4:5], v[22:23], v[8:11]
  ds_read_b64 v[22:23], v103
  s_waitcnt lgkmcnt(5)
  v_mfma_f32_4x4x4_16b_bf16 v[8:11], v[4:5], v[24:25], v[8:11]
  ds_read_b64 v[24:25], v104
  s_waitcnt lgkmcnt(5)
  v_mfma_f32_4x4x4_16b_bf16 v[8:11], v[4:5], v[26:27], v[8:11]
  ds_read_b64 v[26:27], v105
  s_waitcnt lgkmcnt(5)
  v_mfma_f32_4x4x4_16b_bf16 v[8:11], v[4:5], v[16:17], v[8:11]
  ds_read_b64 v[16:17], v106
  s_waitcnt lgkmcnt(5)
  v_mfma_f32_4x4x4_16b_bf16 v[8:11], v[4:5], v[18:19], v[8:11]
  ds_read_b64 v[18:19], v107
  s_waitcnt lgkmcnt(5)
  v_mfma_f32_4x4x4_16b_bf16 v[8:11], v[4:5], v[20:21], v[8:11]
  ds_read_b64 v[20:21], v108
  s_waitcnt lgkmcnt(5)
  v_mfma_f32_4x4x4_16b_bf16 v[8:11], v[4:5], v[22:23], v[8:11]
  ds_read_b64 v[22:23], v109
  s_waitcnt lgkmcnt(5)
  v_mfma_f32_4x4x4_16b_bf16 v[8:11], v[4:5], v[24:25], v[8:11]
  ds_read_b64 v[24:25], v110
  s_waitcnt lgkmcnt(5)
  v_mfma_f32_4x4x4_16b_bf16 v[8:11], v[4:5], v[26:27], v[8:11]
  ds_read_b64 v[26:27], v111
  s_waitcnt lgkmcnt(5)
  v_mfma_f32_4x4x4_16b_bf16 v[8:11], v[4:5], v[16:17], v[8:11]
  ds_read_b64 v[16:17], v112
  s_waitcnt lgkmcnt(5)
  v_mfma_f32_4x4x4_16b_bf16 v[8:11], v[4:5], v[18:19], v[8:11]
  ds_read_b64 v[18:19], v113
  s_waitcnt lgkmcnt(5)
  v_mfma_f32_4x4x4_16b_bf16 v[8:11], v[4:5], v[20:21], v[8:11]
  ds_read_b64 v[20:21], v114
  s_waitcnt lgkmcnt(5)
  v_mfma_f32_4x4x4_16b_bf16 v[8:11], v[4:5], v[22:23], v[8:11]
  ds_read_b64 v[22:23], v115
  s_waitcnt lgkmcnt(5)
  v_mfma_f32_4x4x4_16b_bf16 v[8:11], v[4:5], v[24:25], v[8:11]
  ds_read_b64 v[24:25], v116
  s_waitcnt lgkmcnt(5)
  v_mfma_f32_4x4x4_16b_bf16 v[8:11], v[4:5], v[26:27], v[8:11]
  ds_read_b64 v[26:27], v117
  s_waitcnt lgkmcnt(5)
  v_mfma_f32_4x4x4_16b_bf16 v[8:11], v[4:5], v[16:17], v[8:11]
  ds_read_b64 v[16:17], v118
  s_waitcnt lgkmcnt(5)
  v_mfma_f32_4x4x4_16b_bf16 v[8:11], v[4:5], v[18:19], v[8:11]
  ds_read_b64 v[18:19], v119
  s_waitcnt lgkmcnt(5)
  v_mfma_f32_4x4x4_16b_bf16 v[8:11], v[4:5], v[20:21], v[8:11]
  s_waitcnt lgkmcnt(4)
  s_nop 0
  v_mfma_f32_4x4x4_16b_bf16 v[8:11], v[4:5], v[22:23], v[8:11]
  s_waitcnt lgkmcnt(3)
  s_nop 0
  v_mfma_f32_4x4x4_16b_bf16 v[8:11], v[4:5], v[24:25], v[8:11]
  s_waitcnt lgkmcnt(2)
  s_nop 0
  v_mfma_f32_4x4x4_16b_bf16 v[8:11], v[4:5], v[26:27], v[8:11]
  s_waitcnt lgkmcnt(1)
  s_nop 0
  v_mfma_f32_4x4x4_16b_bf16 v[8:11], v[4:5], v[16:17], v[8:11]
  s_waitcnt lgkmcnt(0)
  s_nop 0
  v_mfma_f32_4x4x4_16b_bf16 v[8:11], v[4:5], v[18:19], v[8:11]
  s_setprio 3
  s_cmp_eq_u32 s21, 0
  s_cbranch_scc1 K3_H12N
K3_H12P:
  v_mov_b32 v12, 125440
  ds_read_b32 v12, v12 offset:8
  s_waitcnt lgkmcnt(0)
  v_readfirstlane_b32 s37, v12
  s_cmp_ge_u32 s37, s18
  s_cbranch_scc1 K3_H12Q
  s_sleep 1
  s_sub_u32 s19, s19, 1
  s_cbranch_scc0 K3_H12P
  s_mov_b32 s19, 0
  s_branch K3_H12Q
K3_H12Q:
  v_add_u32 v13, 124928, v1
  s_mov_b32 exec_hi, 0
  ds_read_b128 v[16:19], v13
  s_waitcnt lgkmcnt(0)
  v_add_f32 v8, v8, v16
  v_add_f32 v9, v9, v17
  v_add_f32 v10, v10, v18
  v_add_f32 v11, v11, v19
  s_mov_b64 exec, -1
K3_H12N:
  s_nop 1
  v_mov_b32 v16, v8
  v_mov_b32 v17, v9
  v_mov_b32 v18, v10
  v_mov_b32 v19, v11
  v_permlane32_swap_b32 v16, v8
  v_permlane32_swap_b32 v17, v9
  v_permlane32_swap_b32 v18, v10
  v_permlane32_swap_b32 v19, v11
  v_add_f32 v8, v8, v16
  v_add_f32 v9, v9, v17
  v_add_f32 v10, v10, v18
  v_add_f32 v11, v11, v19
  v_mul_f32 v8, v8, v3
  v_mul_f32 v9, v9, v3
  v_mul_f32 v10, v10, v3
  v_mul_f32 v11, v11, v3
  v_cvt_pk_bf16_f32 v6, v8, v9
  v_cvt_pk_bf16_f32 v7, v10, v11
  v_mul_f32 v8, v8, v3
  v_mul_f32 v9, v9, v3
  v_mul_f32 v10, v10, v3
  v_mul_f32 v11, v11, v3
  v_add_u32 v8, s17, v8
  v_add_u32 v10, s17, v10
  v_bfi_b32 v8, s31, v0, v8
  v_bfi_b32 v10, s31, v0, v10
  v_cvt_pk_bf16_f32 v8, v8, v9
  v_cvt_pk_bf16_f32 v9, v10, v11
  s_mov_b32 exec_hi, 0
  s_cmp_eq_u32 s20, 1
  s_cbranch_scc0 L_k3_56
  buffer_store_dwordx2 v[8:9], v2, s[12:15], 0 offen
L_k3_57:
  s_cmp_lg_u32 s18, 7
  s_cbranch_scc1 K3_MOVE
  buffer_store_dwordx2 v[6:7], v31, s[8:11], s22 offen sc1
K3_MOVE:
  s_waitcnt lgkmcnt(0)
  s_cmp_eq_u32 s18, 7
  s_cbranch_scc1 K3_END
  s_mov_b64 exec, -1
  v_mov_b32 v15, 125440
  v_mov_b32 v12, 1
  s_mov_b64 exec, 1
  ds_add_u32 v15, v12 offset:12
  s_mov_b64 exec, -1
  v_add_u32 v16, 50176, v1
  v_add_u32 v17, 50176, v83
  s_mov_b64 exec, 195
PL_k3_58:
  buffer_load_dwordx4 v[84:87], v83, s[12:15], s26 offen sc1
  s_waitcnt vmcnt(0)
  v_bitop3_b32 v12, v84, v86, s16 bitop3:0x7e
  v_and_b32 v12, 1, v12
  v_cmp_ne_u32 vcc, 0, v12
  s_cbranch_vccz L_k3_59
  s_sleep 1
  s_sub_u32 s19, s19, 1
  s_cbranch_scc0 PL_k3_58
  s_mov_b32 s19, 0
L_k3_59:
  s_mov_b64 exec, -1
  buffer_load_dwordx4 v[32:35], v1, s[12:15], s26 offen offset:0 sc1
  buffer_load_dwordx4 v[36:39], v1, s[12:15], s26 offen offset:1024 sc1
  buffer_load_dwordx4 v[56:59], v1, s[12:15], s27 offen offset:2048 sc1
  buffer_load_dwordx4 v[60:63], v1, s[12:15], s27 offen offset:3072 sc1
  s_mov_b64 exec, 780
PL_k3_60:
  buffer_load_dwordx4 v[84:87], v83, s[12:15], s26 offen sc1
  s_waitcnt vmcnt(0)
  v_bitop3_b32 v12, v84, v86, s16 bitop3:0x7e
  v_and_b32 v12, 1, v12
  v_cmp_ne_u32 vcc, 0, v12
  s_cbranch_vccz L_k3_61
  s_sleep 1
  s_sub_u32 s19, s19, 1
  s_cbranch_scc0 PL_k3_60
  s_mov_b32 s19, 0
L_k3_61:
  s_mov_b64 exec, -1
  buffer_load_dwordx4 v[40:43], v1, s[12:15], s26 offen offset:2048 sc1
  buffer_load_dwordx4 v[44:47], v1, s[12:15], s26 offen offset:3072 sc1
  buffer_load_dwordx4 v[64:67], v1, s[12:15], s28 offen offset:0 sc1
  buffer_load_dwordx4 v[68:71], v1, s[12:15], s28 offen offset:1024 sc1
  ds_read_b32 v12, v15 offset:12
L_k3_62:
  s_waitcnt lgkmcnt(0)
  v_readfirstlane_b32 s37, v12
  s_cmp_ge_u32 s37, s46
  s_cbranch_scc0 L_k3_63
L_k3_64:
  buffer_load_dwordx4 v[48:51], v1, s[12:15], s27 offen offset:0 sc1
  buffer_load_dwordx4 v[52:55], v1, s[12:15], s27 offen offset:1024 sc1
  buffer_load_dwordx4 v[72:75], v1, s[12:15], s28 offen offset:2048 sc1
  buffer_load_dwordx4 v[76:79], v1, s[12:15], s28 offen offset:3072 sc1
  buffer_load_dwordx2 v[80:81], v82, s[12:15], 0 offen sc1
VF_k3_65:
  v_bitop3_b32 v12, v32, v34, s16 bitop3:0x7e
  v_bitop3_b32 v13, v36, v38, s16 bitop3:0x7e
  v_or_b32 v14, v12, v13
  v_bitop3_b32 v12, v56, v58, s16 bitop3:0x7e
  v_bitop3_b32 v13, v60, v62, s16 bitop3:0x7e
  v_or3_b32 v14, v12, v13, v14
  v_and_b32 v14, 1, v14
  v_cmp_ne_u32 vcc, 0, v14
  s_cbranch_vccnz L_k3_66
L_k3_67:
  ds_write_addtid_b32 v32 offset:0
  ds_write_addtid_b32 v33 offset:256
  ds_write_addtid_b32 v34 offset:512
  ds_write_addtid_b32 v35 offset:768
  ds_write_addtid_b32 v36 offset:1024
  ds_write_addtid_b32 v37 offset:1280
  ds_write_addtid_b32 v38 offset:1536
  ds_write_addtid_b32 v39 offset:1792
  ds_write_addtid_b32 v56 offset:6144
  ds_write_addtid_b32 v57 offset:6400
  ds_write_addtid_b32 v58 offset:6656
  ds_write_addtid_b32 v59 offset:6912
  ds_write_addtid_b32 v60 offset:7168
  ds_write_addtid_b32 v61 offset:7424
  ds_write_addtid_b32 v62 offset:7680
  ds_write_addtid_b32 v63 offset:7936
  s_waitcnt vmcnt(5)
VF_k3_68:
  v_bitop3_b32 v12, v40, v42, s16 bitop3:0x7e
  v_bitop3_b32 v13, v44, v46, s16 bitop3:0x7e
  v_or_b32 v14, v12, v13
  v_bitop3_b32 v12, v64, v66, s16 bitop3:0x7e
  v_bitop3_b32 v13, v68, v70, s16 bitop3:0x7e
  v_or3_b32 v14, v12, v13, v14
  v_and_b32 v14, 1, v14
  v_cmp_ne_u32 vcc, 0, v14
  s_cbranch_vccnz L_k3_69
L_k3_70:
  ds_write_addtid_b32 v40 offset:2048
  ds_write_addtid_b32 v41 offset:2304
  ds_write_addtid_b32 v42 offset:2560
  ds_write_addtid_b32 v43 offset:2816
  ds_write_addtid_b32 v44 offset:3072
  ds_write_addtid_b32 v45 offset:3328
  ds_write_addtid_b32 v46 offset:3584
  ds_write_addtid_b32 v47 offset:3840
  ds_write_addtid_b32 v64 offset:8192
  ds_write_addtid_b32 v65 offset:8448
  ds_write_addtid_b32 v66 offset:8704
  ds_write_addtid_b32 v67 offset:8960
  ds_write_addtid_b32 v68 offset:9216
  ds_write_addtid_b32 v69 offset:9472
  ds_write_addtid_b32 v70 offset:9728
  ds_write_addtid_b32 v71 offset:9984
  s_waitcnt vmcnt(0)
VF_k3_71:
  v_bitop3_b32 v12, v48, v50, s16 bitop3:0x7e
  v_bitop3_b32 v13, v52, v54, s16 bitop3:0x7e
  v_xor_b32 v14, s16, v80
  v_or3_b32 v14, v12, v13, v14
  v_bitop3_b32 v12, v72, v74, s16 bitop3:0x7e
  v_bitop3_b32 v13, v76, v78, s16 bitop3:0x7e
  v_or3_b32 v14, v12, v13, v14
  v_and_b32 v14, 1, v14
  v_cmp_ne_u32 vcc, 0, v14
  s_cbranch_vccnz L_k3_72
L_k3_73:
  ds_write_addtid_b32 v48 offset:4096
  ds_write_addtid_b32 v49 offset:4352
  ds_write_addtid_b32 v50 offset:4608
  ds_write_addtid_b32 v51 offset:4864
  ds_write_addtid_b32 v52 offset:5120
  ds_write_addtid_b32 v53 offset:5376
  ds_write_addtid_b32 v54 offset:5632
  ds_write_addtid_b32 v55 offset:5888
  ds_write_addtid_b32 v72 offset:10240
  ds_write_addtid_b32 v73 offset:10496
  ds_write_addtid_b32 v74 offset:10752
  ds_write_addtid_b32 v75 offset:11008
  ds_write_addtid_b32 v76 offset:11264
  ds_write_addtid_b32 v77 offset:11520
  ds_write_addtid_b32 v78 offset:11776
  ds_write_addtid_b32 v79 offset:12032
  ds_write_b64 v82, v[80:81]
  buffer_load_dwordx4 v[18:21], v16, s[12:15], s26 offen offset:0 sc1
  buffer_load_dwordx4 v[22:25], v16, s[12:15], s26 offen offset:1024 sc1
  buffer_load_dwordx4 v[26:29], v16, s[12:15], s27 offen offset:2048 sc1
  buffer_load_dwordx4 v[120:123], v16, s[12:15], s27 offen offset:3072 sc1
  s_waitcnt lgkmcnt(15)
  buffer_load_dwordx4 v[40:43], v16, s[12:15], s26 offen offset:2048 sc1
  buffer_load_dwordx4 v[44:47], v16, s[12:15], s26 offen offset:3072 sc1
  buffer_load_dwordx4 v[64:67], v16, s[12:15], s28 offen offset:0 sc1
  buffer_load_dwordx4 v[68:71], v16, s[12:15], s28 offen offset:1024 sc1
  s_waitcnt lgkmcnt(0)
  s_barrier
  s_waitcnt lgkmcnt(15)
  buffer_load_dwordx4 v[48:51], v16, s[12:15], s27 offen offset:0 sc1
  buffer_load_dwordx4 v[52:55], v16, s[12:15], s27 offen offset:1024 sc1
  buffer_load_dwordx4 v[72:75], v16, s[12:15], s28 offen offset:2048 sc1
  buffer_load_dwordx4 v[76:79], v16, s[12:15], s28 offen offset:3072 sc1
  s_waitcnt vmcnt(8)
VF_k3_74:
  v_bitop3_b32 v12, v18, v20, s16 bitop3:0x7e
  v_bitop3_b32 v13, v22, v24, s16 bitop3:0x7e
  v_or_b32 v14, v12, v13
  v_bitop3_b32 v12, v26, v28, s16 bitop3:0x7e
  v_bitop3_b32 v13, v120, v122, s16 bitop3:0x7e
  v_or3_b32 v14, v12, v13, v14
  v_and_b32 v14, 1, v14
  v_cmp_ne_u32 vcc, 0, v14
  s_cbranch_vccnz L_k3_75
L_k3_76:
  ds_write_addtid_b32 v18 offset:50176
  ds_write_addtid_b32 v19 offset:50432
  ds_write_addtid_b32 v20 offset:50688
  ds_write_addtid_b32 v21 offset:50944
  ds_write_addtid_b32 v22 offset:51200
  ds_write_addtid_b32 v23 offset:51456
  ds_write_addtid_b32 v24 offset:51712
  ds_write_addtid_b32 v25 offset:51968
  ds_write_addtid_b32 v26 offset:56320
  ds_write_addtid_b32 v27 offset:56576
  ds_write_addtid_b32 v28 offset:56832
  ds_write_addtid_b32 v29 offset:57088
  ds_write_addtid_b32 v120 offset:57344
  ds_write_addtid_b32 v121 offset:57600
  ds_write_addtid_b32 v122 offset:57856
  ds_write_addtid_b32 v123 offset:58112
  s_waitcnt vmcnt(4)
VF_k3_77:
  v_bitop3_b32 v12, v40, v42, s16 bitop3:0x7e
  v_bitop3_b32 v13, v44, v46, s16 bitop3:0x7e
  v_or_b32 v14, v12, v13
  v_bitop3_b32 v12, v64, v66, s16 bitop3:0x7e
  v_bitop3_b32 v13, v68, v70, s16 bitop3:0x7e
  v_or3_b32 v14, v12, v13, v14
  v_and_b32 v14, 1, v14
  v_cmp_ne_u32 vcc, 0, v14
  s_cbranch_vccnz L_k3_78
L_k3_79:
  ds_write_addtid_b32 v40 offset:52224
  ds_write_addtid_b32 v41 offset:52480
  ds_write_addtid_b32 v42 offset:52736
  ds_write_addtid_b32 v43 offset:52992
  ds_write_addtid_b32 v44 offset:53248
  ds_write_addtid_b32 v45 offset:53504
  ds_write_addtid_b32 v46 offset:53760
  ds_write_addtid_b32 v47 offset:54016
  ds_write_addtid_b32 v64 offset:58368
  ds_write_addtid_b32 v65 offset:58624
  ds_write_addtid_b32 v66 offset:58880
  ds_write_addtid_b32 v67 offset:59136
  ds_write_addtid_b32 v68 offset:59392
  ds_write_addtid_b32 v69 offset:59648
  ds_write_addtid_b32 v70 offset:59904
  ds_write_addtid_b32 v71 offset:60160
  s_waitcnt vmcnt(0)
VF_k3_80:
  v_bitop3_b32 v12, v48, v50, s16 bitop3:0x7e
  v_bitop3_b32 v13, v52, v54, s16 bitop3:0x7e
  v_or_b32 v14, v12, v13
  v_bitop3_b32 v12, v72, v74, s16 bitop3:0x7e
  v_bitop3_b32 v13, v76, v78, s16 bitop3:0x7e
  v_or3_b32 v14, v12, v13, v14
  v_and_b32 v14, 1, v14
  v_cmp_ne_u32 vcc, 0, v14
  s_cbranch_vccnz L_k3_81
L_k3_82:
  ds_write_addtid_b32 v48 offset:54272
  ds_write_addtid_b32 v49 offset:54528
  ds_write_addtid_b32 v50 offset:54784
  ds_write_addtid_b32 v51 offset:55040
  ds_write_addtid_b32 v52 offset:55296
  ds_write_addtid_b32 v53 offset:55552
  ds_write_addtid_b32 v54 offset:55808
  ds_write_addtid_b32 v55 offset:56064
  ds_write_addtid_b32 v72 offset:60416
  ds_write_addtid_b32 v73 offset:60672
  ds_write_addtid_b32 v74 offset:60928
  ds_write_addtid_b32 v75 offset:61184
  ds_write_addtid_b32 v76 offset:61440
  ds_write_addtid_b32 v77 offset:61696
  ds_write_addtid_b32 v78 offset:61952
  ds_write_addtid_b32 v79 offset:62208
  v_mov_b32 v12, 1
  s_mov_b64 exec, 1
  ds_add_u32 v15, v12 offset:16
  s_mov_b64 exec, -1
  s_cmp_lg_u32 s3, 12
  s_cbranch_scc1 K3_M2
  s_mov_b32 exec_hi, 0
  buffer_store_dwordx2 v[6:7], v31, s[8:11], s22 offen sc1
  s_mov_b64 exec, -1
K3_M2:
  s_add_u32 s18, s18, 1
  s_add_u32 s46, s46, 16
  s_add_u32 s38, s38, 4
  s_xor_b64 s[12:13], s[12:13], s[24:25]
  s_add_u32 s22, s22, 3211264
  s_bfe_i32 s16, s18, 0x10001
  s_andn2_b32 s17, 0x10000, s16
  v_lshlrev_b32 v0, 16, s16
  s_cmp_eq_u32 s18, 7
  s_cselect_b32 s20, 0, s20
  s_branch K3_ALOOP
L_k3_56:
  s_cmp_eq_u32 s20, 2
  s_cbranch_scc0 L_k3_57
  buffer_store_dwordx2 v[8:9], v2, s[12:15], 0 offen sc1
  s_branch L_k3_57
L_k3_63:
  s_sleep 1
  ds_read_b32 v12, v15 offset:12
  s_sub_u32 s19, s19, 1
  s_cbranch_scc0 L_k3_62
  s_mov_b32 s19, 0
  s_branch L_k3_64
L_k3_66:
  buffer_load_dwordx4 v[32:35], v1, s[12:15], s26 offen offset:0 sc1
  buffer_load_dwordx4 v[36:39], v1, s[12:15], s26 offen offset:1024 sc1
  buffer_load_dwordx4 v[56:59], v1, s[12:15], s27 offen offset:2048 sc1
  buffer_load_dwordx4 v[60:63], v1, s[12:15], s27 offen offset:3072 sc1
  s_waitcnt vmcnt(0)
  s_sub_u32 s19, s19, 1
  s_cbranch_scc0 VF_k3_65
  s_mov_b32 s19, 0
  s_branch L_k3_67
L_k3_69:
  buffer_load_dwordx4 v[40:43], v1, s[12:15], s26 offen offset:2048 sc1
  buffer_load_dwordx4 v[44:47], v1, s[12:15], s26 offen offset:3072 sc1
  buffer_load_dwordx4 v[64:67], v1, s[12:15], s28 offen offset:0 sc1
  buffer_load_dwordx4 v[68:71], v1, s[12:15], s28 offen offset:1024 sc1
  s_waitcnt vmcnt(0)
  s_sub_u32 s19, s19, 1
  s_cbranch_scc0 VF_k3_68
  s_mov_b32 s19, 0
  s_branch L_k3_70
L_k3_72:
  buffer_load_dwordx4 v[48:51], v1, s[12:15], s27 offen offset:0 sc1
  buffer_load_dwordx4 v[52:55], v1, s[12:15], s27 offen offset:1024 sc1
  buffer_load_dwordx4 v[72:75], v1, s[12:15], s28 offen offset:2048 sc1
  buffer_load_dwordx4 v[76:79], v1, s[12:15], s28 offen offset:3072 sc1
  buffer_load_dwordx2 v[80:81], v82, s[12:15], 0 offen sc1
  s_waitcnt vmcnt(0)
  s_sub_u32 s19, s19, 1
  s_cbranch_scc0 VF_k3_71
  s_mov_b32 s19, 0
  s_branch L_k3_73
L_k3_75:
  buffer_load_dwordx4 v[18:21], v16, s[12:15], s26 offen offset:0 sc1
  buffer_load_dwordx4 v[22:25], v16, s[12:15], s26 offen offset:1024 sc1
  buffer_load_dwordx4 v[26:29], v16, s[12:15], s27 offen offset:2048 sc1
  buffer_load_dwordx4 v[120:123], v16, s[12:15], s27 offen offset:3072 sc1
  s_waitcnt vmcnt(0)
  s_sub_u32 s19, s19, 1
  s_cbranch_scc0 VF_k3_74
  s_mov_b32 s19, 0
  s_branch L_k3_76
L_k3_78:
  buffer_load_dwordx4 v[40:43], v16, s[12:15], s26 offen offset:2048 sc1
  buffer_load_dwordx4 v[44:47], v16, s[12:15], s26 offen offset:3072 sc1
  buffer_load_dwordx4 v[64:67], v16, s[12:15], s28 offen offset:0 sc1
  buffer_load_dwordx4 v[68:71], v16, s[12:15], s28 offen offset:1024 sc1
  s_waitcnt vmcnt(0)
  s_sub_u32 s19, s19, 1
  s_cbranch_scc0 VF_k3_77
  s_mov_b32 s19, 0
  s_branch L_k3_79
L_k3_81:
  buffer_load_dwordx4 v[48:51], v16, s[12:15], s27 offen offset:0 sc1
  buffer_load_dwordx4 v[52:55], v16, s[12:15], s27 offen offset:1024 sc1
  buffer_load_dwordx4 v[72:75], v16, s[12:15], s28 offen offset:2048 sc1
  buffer_load_dwordx4 v[76:79], v16, s[12:15], s28 offen offset:3072 sc1
  s_waitcnt vmcnt(0)
  s_sub_u32 s19, s19, 1
  s_cbranch_scc0 VF_k3_80
  s_mov_b32 s19, 0
  s_branch L_k3_82
.globl k4_kernel
.p2align 8
.type k4_kernel,@function
k4_kernel:
  s_cmp_ge_u32 s2, 256
  s_cbranch_scc1 K4_END
  s_load_dwordx2 s[8:9], s[0:1], 88
  s_load_dwordx2 s[12:13], s[0:1], 0
  s_load_dwordx2 s[16:17], s[0:1], 72
  v_lshrrev_b32 v2, 6, v0
  v_and_b32 v1, 63, v0
  v_readfirstlane_b32 s3, v2
  v_lshlrev_b32 v0, 4, v1
  v_and_b32 v2, 3, v1
  v_lshl_or_b32 v2, v2, 10, v0
  s_mov_b32 s10, 268435456
  s_mov_b32 s11, 0x00020000
  s_mov_b32 s14, 3200000
  s_mov_b32 s15, 0x00020000
  s_mov_b32 s7, 393216
  s_mov_b32 s47, 327680
  s_lshr_b32 s4, s3, 2
  s_and_b32 s5, s3, 3
  v_mov_b32 v5, 98304
  v_mov_b32 v4, 0
  s_cmp_ge_u32 s3, 12
  s_cbranch_scc1 K4_E
  s_lshl_b32 s46, s5, 1
  s_lshl_b32 s44, s5, 13
  s_mul_i32 s48, s2, 384
  s_lshl_b32 s6, s4, 7
  s_add_u32 s48, s48, s6
  s_mul_i32 s6, s46, 3211264
  s_add_u32 s48, s48, s6
  s_add_u32 s48, s48, 67108864
  s_sub_u32 s40, s48, 3211264
  s_mul_i32 s41, s2, 12288
  s_lshl_b32 s6, s4, 12
  s_add_u32 s41, s41, s6
  s_movk_i32 s42, 256
  s_movk_i32 s45, 512
  s_cmp_eq_u32 s46, 0
  s_cselect_b32 s40, s41, s40
  s_cselect_b32 s41, 16, 200704
  s_cselect_b32 s43, 64, 802816
  s_cselect_b32 s42, s42, 100352
  s_cselect_b32 s45, s45, 16
  v_xor_b32 v3, s46, v1
  v_bfe_u32 v6, v3, 4, 1
  v_and_b32 v7, 3, v3
  v_lshl_or_b32 v6, v6, 2, v7
  v_lshrrev_b32 v7, 5, v3
  v_bfe_u32 v9, v3, 2, 1
  v_bfe_u32 v3, v3, 3, 1
  v_lshl_or_b32 v9, v9, 1, v3
  v_mul_u32_u24 v8, s45, v6
  v_mad_u32_u24 v8, v7, s42, v8
  v_mad_u32_u24 v8, v9, s43, v8
  v_xor_b32 v6, 1, v6
  v_lshl_add_u32 v9, v9, 3, v7
  v_mul_u32_u24 v9, 100352, v9
  v_lshl_add_u32 v9, v6, 4, v9
  s_lshl_b32 s6, s4, 15
  s_add_u32 s45, s44, s6
  s_add_u32 s42, s45, 294912
  s_add_u32 s43, s42, 4096
  s_waitcnt lgkmcnt(0)
  s_cmp_eq_u32 s46, 0
  s_cselect_b64 s[24:25], s[12:13], s[8:9]
  s_cselect_b64 s[26:27], s[14:15], s[10:11]
  s_and_b32 s9, s9, 0xffff
  s_and_b32 s25, s25, 0xffff
  s_cmp_eq_u32 s4, 0
  s_cbranch_scc1 K4_L0
  s_add_u32 m0, s45, 65536
  s_cmp_eq_u32 s3, 4
  s_cbranch_scc1 K4_L1
  s_cmp_eq_u32 s4, 1
  s_cbranch_scc1 K4_L7
  s_barrier
K4_L6:
  ds_read_b32 v3, v5
  s_waitcnt lgkmcnt(0)
  v_readfirstlane_b32 s49, v3
  s_bitcmp0_b32 s49, 14
  s_cbranch_scc0 K4_L7
  s_sleep 1
  s_branch K4_L6
K4_L7:
  buffer_load_dwordx4 v0, s[8:11], s42 offen lds
K4_L1:
  buffer_load_dwordx4 v0, s[8:11], s42 offen offset:1024 lds
  buffer_load_dwordx4 v0, s[8:11], s42 offen offset:2048 lds
  buffer_load_dwordx4 v0, s[8:11], s42 offen offset:3072 lds
  s_add_u32 m0, s45, 69632
  s_nop 0
  buffer_load_dwordx4 v0, s[8:11], s43 offen offset:0 lds
  buffer_load_dwordx4 v0, s[8:11], s43 offen offset:1024 lds
  buffer_load_dwordx4 v0, s[8:11], s43 offen offset:2048 lds
  buffer_load_dwordx4 v0, s[8:11], s43 offen offset:3072 lds
  s_lshl_b32 s6, s4, 2
  s_lshl_b32 s6, 1, s6
  v_mov_b32 v4, s6
  s_cmp_eq_u32 s4, 1
  s_cbranch_scc1 K4_L2
  s_waitcnt vmcnt(0)
  s_mov_b64 exec, 1
  ds_add_u32 v5, v4
  s_mov_b64 exec, -1
  v_mov_b32 v4, 0
K4_L3:
  ds_read_b32 v3, v5
  s_waitcnt lgkmcnt(0)
  v_readfirstlane_b32 s49, v3
  s_bitcmp0_b32 s49, 22
  s_cbranch_scc0 K4_L0
  s_sleep 1
  s_branch K4_L3
K4_L2:
  s_barrier
K4_L4:
  ds_read_b32 v3, v5
  s_waitcnt lgkmcnt(0)
  v_readfirstlane_b32 s49, v3
  s_bitcmp0_b32 s49, 14
  s_cbranch_scc0 K4_L0
  s_sleep 1
  s_branch K4_L4
K4_L0:
  s_mov_b32 m0, s45
  s_nop 0
  buffer_load_dwordx4 v8, s[24:27], s40 offen lds
  s_add_u32 s40, s40, s41
  s_add_u32 m0, m0, 1024
  s_nop 0
  buffer_load_dwordx4 v8, s[24:27], s40 offen lds
  s_add_u32 s40, s40, s41
  s_add_u32 m0, m0, 1024
  s_nop 0
  buffer_load_dwordx4 v8, s[24:27], s40 offen lds
  s_add_u32 s40, s40, s41
  s_add_u32 m0, m0, 1024
  s_nop 0
  buffer_load_dwordx4 v8, s[24:27], s40 offen lds
  s_add_u32 s40, s40, s41
  s_add_u32 m0, m0, 1024
  s_nop 0
  buffer_load_dwordx4 v9, s[8:11], s48 offen lds
  s_add_u32 s48, s48, 200704
  s_add_u32 m0, m0, 1024
  s_nop 0
  buffer_load_dwordx4 v9, s[8:11], s48 offen lds
  s_add_u32 s48, s48, 200704
  s_add_u32 m0, m0, 1024
  s_nop 0
  buffer_load_dwordx4 v9, s[8:11], s48 offen lds
  s_add_u32 s48, s48, 200704
  s_add_u32 m0, m0, 1024
  s_nop 0
  buffer_load_dwordx4 v9, s[8:11], s48 offen lds
  buffer_load_dwordx4 v[88:91], v2, s[8:11], s7 offen
  buffer_load_dwordx4 v[104:107], v0, s[8:11], s47 offen
  s_cmp_lg_u32 s4, 0
  s_cbranch_scc1 K4_L5
  ds_write_b32 v5, v4
  s_waitcnt lgkmcnt(0)
  s_barrier
K4_L5:
  s_waitcnt vmcnt(10)
  s_mov_b64 exec, 1
  ds_add_u32 v5, v4
  s_mov_b64 exec, -1
  s_branch K4_C
K4_E:
  s_cmp_lg_u32 s3, 12
  s_cbranch_scc1 K4_END
  s_cmp_ge_u32 s2, 106
  s_cbranch_scc1 K4_END
  v_and_b32 v3, 7, v1
  v_lshrrev_b32 v8, 4, v1
  v_bfe_u32 v9, v1, 3, 1
  v_mul_u32_u24 v6, 3211264, v3
  v_mul_u32_u24 v7, 802816, v8
  v_add_u32 v6, v6, v7
  v_lshl_add_u32 v6, v9, 3, v6
  v_lshlrev_b32 v7, 6, v8
  v_lshl_or_b32 v7, v9, 8, v7
  s_lshl_b32 s45, s2, 4
  s_add_u32 s45, s45, 63995904
  s_lshl_b32 s43, s2, 9
  s_add_u32 s43, s43, 3145728
  s_mov_b32 exec_lo, 0x01010101
  s_mov_b32 exec_hi, 0x01010101
  s_waitcnt lgkmcnt(0)
  s_and_b32 s9, s9, 0xffff
  s_and_b32 s13, s13, 0xffff
  buffer_load_dwordx4 v[10:13], v7, s[12:15], s43 offen offset:0
  buffer_load_dwordx4 v[16:19], v7, s[12:15], s43 offen offset:16
  buffer_load_dwordx4 v[22:25], v7, s[12:15], s43 offen offset:32
  buffer_load_dwordx4 v[28:31], v7, s[12:15], s43 offen offset:48
  s_not_b64 exec, exec
  buffer_load_dwordx2 v[10:11], v6, s[8:11], s45 offen
  s_add_u32 s45, s45, 100352
  buffer_load_dwordx2 v[12:13], v6, s[8:11], s45 offen
  s_add_u32 s45, s45, 100352
  buffer_load_dwordx2 v[16:17], v6, s[8:11], s45 offen
  s_add_u32 s45, s45, 100352
  buffer_load_dwordx2 v[18:19], v6, s[8:11], s45 offen
  s_add_u32 s45, s45, 100352
  buffer_load_dwordx2 v[22:23], v6, s[8:11], s45 offen
  s_add_u32 s45, s45, 100352
  buffer_load_dwordx2 v[24:25], v6, s[8:11], s45 offen
  s_add_u32 s45, s45, 100352
  buffer_load_dwordx2 v[28:29], v6, s[8:11], s45 offen
  s_add_u32 s45, s45, 100352
  buffer_load_dwordx2 v[30:31], v6, s[8:11], s45 offen
  s_mov_b64 exec, -1
  buffer_load_dwordx4 v[88:91], v2, s[8:11], s7 offen
  buffer_load_dwordx4 v[104:107], v0, s[8:11], s47 offen
  s_barrier
K4_C:
  s_load_dword s20, s[8:9], 397312
  s_and_b32 s17, s17, 0xffff
  s_mov_b32 s18, 3200000
  s_mov_b32 s19, 0x00020000
  s_mov_b32 s21, 0xbe27c5ac
  s_mov_b32 s22, 0xbc000000
  s_mov_b32 s23, 0x3aa7c5ac
  s_mov_b32 s28, 0x418293ee
  s_mov_b32 s30, 0xaaaaaaaa
  s_mov_b32 s31, 0xaaaaaaaa
  s_mov_b32 s32, 0xcccccccc
  s_mov_b32 s33, 0xcccccccc
  s_mov_b32 s34, 0xf0f0f0f0
  s_mov_b32 s35, 0xf0f0f0f0
  s_mov_b32 s36, 0x00ff00ff
  s_mov_b32 s37, 0xff00ff00
  s_mov_b32 s38, 0x33333333
  s_mov_b32 s39, 0x33333333
  s_lshl_b32 s6, s4, 15
  s_mul_i32 s29, s2, 48
  s_lshl_b32 s7, s4, 4
  s_add_u32 s29, s29, s7
  s_lshl_b32 s7, s5, 1
  s_add_u32 s29, s29, s7
  s_lshl_b32 s29, s29, 8
  v_add_u32 v0, 98304, v0
  v_and_b32 v112, 7, v1
  v_bfe_u32 v113, v1, 3, 1
  v_lshrrev_b32 v114, 4, v1
  v_lshrrev_b32 v115, 1, v114
  v_lshl_or_b32 v115, v115, 2, s5
  v_xor_b32 v115, v115, v112
  v_lshl_add_u32 v115, v115, 4, s6
  v_and_b32 v114, 1, v114
  v_lshl_add_u32 v115, v114, 7, v115
  v_lshl_add_u32 v115, v112, 12, v115
  v_cmp_eq_u32 vcc, 0, v112
  s_nop 1
  v_cndmask_b32 v114, 3, 9, vcc
  v_lshl_add_u32 v6, v113, v114, v115
  v_cndmask_b32 v114, 9, 3, vcc
  v_lshl_add_u32 v7, 1, v114, v6
  v_bfe_u32 v112, v1, 2, 2
  v_lshrrev_b32 v113, 4, v1
  v_cmp_eq_u32 vcc, v112, v113
  v_mov_b32 v112, 0x3f80
  s_nop 0
  v_cndmask_b32 v112, 0, v112, vcc
  v_lshlrev_b32 v113, 16, v112
  v_cndmask_b32 v112, v112, v113, s[30:31]
  v_cndmask_b32 v122, v112, 0, s[32:33]
  v_cndmask_b32 v123, 0, v112, s[32:33]
  v_mov_b32 v3, 0x05040100
  v_mov_b32 v112, 0x03020706
  v_cndmask_b32 v3, v3, v112, s[30:31]
  v_bfe_u32 v112, v1, 2, 3
  v_lshrrev_b32 v113, 5, v1
  v_and_b32 v114, 3, v1
  v_lshrrev_b32 v115, 1, v114
  v_lshl_or_b32 v115, v115, 2, s5
  v_xor_b32 v115, v115, v112
  v_lshl_add_u32 v115, v115, 4, s6
  v_and_b32 v114, 1, v114
  v_lshl_add_u32 v115, v114, 7, v115
  v_lshl_add_u32 v115, v112, 12, v115
  v_cmp_eq_u32 vcc, 0, v112
  s_nop 1
  v_cndmask_b32 v114, 3, 9, vcc
  v_lshl_add_u32 v1, v113, v114, v115
  v_cndmask_b32 v114, 9, 3, vcc
  v_lshl_add_u32 v2, 1, v114, v1
  s_lshl_b32 s41, s4, 3
  s_lshl_b32 s41, 0x1000, s41
  v_mov_b32 v4, s41
  s_mov_b64 exec, 1
  s_waitcnt vmcnt(6)
  ds_add_u32 v5, v4
  s_lshl_b32 s41, s41, 4
  s_cmp_eq_u32 s4, 2
  s_cselect_b32 s41, 1, s41
  v_mov_b32 v4, s41
  s_waitcnt vmcnt(2)
  ds_add_u32 v5, v4
  s_mov_b64 exec, -1
  s_lshl_b32 s41, s41, 2
  s_or_b32 s41, s41, 0x40
  s_cmp_eq_u32 s4, 3
  s_cselect_b32 s41, 0x440, s41
  s_waitcnt vmcnt(0)
  v_mov_b32_dpp v72, v88 quad_perm:[0,0,0,0] row_mask:0xf bank_mask:0xf
  v_mov_b32_dpp v73, v89 quad_perm:[0,0,0,0] row_mask:0xf bank_mask:0xf
  v_mov_b32_dpp v74, v90 quad_perm:[0,0,0,0] row_mask:0xf bank_mask:0xf
  v_mov_b32_dpp v75, v91 quad_perm:[0,0,0,0] row_mask:0xf bank_mask:0xf
  v_mov_b32_dpp v76, v88 quad_perm:[1,1,1,1] row_mask:0xf bank_mask:0xf
  v_mov_b32_dpp v77, v89 quad_perm:[1,1,1,1] row_mask:0xf bank_mask:0xf
  v_mov_b32_dpp v78, v90 quad_perm:[1,1,1,1] row_mask:0xf bank_mask:0xf
  v_mov_b32_dpp v79, v91 quad_perm:[1,1,1,1] row_mask:0xf bank_mask:0xf
  v_mov_b32_dpp v80, v88 quad_perm:[2,2,2,2] row_mask:0xf bank_mask:0xf
  v_mov_b32_dpp v81, v89 quad_perm:[2,2,2,2] row_mask:0xf bank_mask:0xf
  v_mov_b32_dpp v82, v90 quad_perm:[2,2,2,2] row_mask:0xf bank_mask:0xf
  v_mov_b32_dpp v83, v91 quad_perm:[2,2,2,2] row_mask:0xf bank_mask:0xf
  v_mov_b32_dpp v84, v88 quad_perm:[3,3,3,3] row_mask:0xf bank_mask:0xf
  v_mov_b32_dpp v85, v89 quad_perm:[3,3,3,3] row_mask:0xf bank_mask:0xf
  v_mov_b32_dpp v86, v90 quad_perm:[3,3,3,3] row_mask:0xf bank_mask:0xf
  v_mov_b32_dpp v87, v91 quad_perm:[3,3,3,3] row_mask:0xf bank_mask:0xf
K4_PL:
  ds_read_b32 v120, v0
  s_waitcnt lgkmcnt(0)
  v_readfirstlane_b32 s49, v120
  s_andn2_b32 s49, s41, s49
  s_cbranch_scc0 K4_GO
  s_sleep 1
  s_branch K4_PL
K4_GO:
  s_setprio 2
  s_cmp_eq_u32 s3, 12
  s_cbranch_scc1 K4_X
  ds_read_b64 v[8:9], v6 offset:0
  ds_read_b64 v[10:11], v7 offset:0
  ds_read_b64 v[24:25], v6 offset:256
  ds_read_b64 v[26:27], v7 offset:256
  ds_read_b64 v[12:13], v6 offset:1024
  ds_read_b64 v[14:15], v7 offset:1024
  ds_read_b64 v[28:29], v6 offset:1280
  ds_read_b64 v[30:31], v7 offset:1280
  ds_read_b64 v[16:17], v6 offset:2048
  ds_read_b64 v[18:19], v7 offset:2048
  ds_read_b64 v[32:33], v6 offset:2304
  ds_read_b64 v[34:35], v7 offset:2304
  s_mov_b64 vcc, s[38:39]
  ds_read_b64 v[20:21], v6 offset:3072
  s_waitcnt lgkmcnt(11)
  v_mfma_f32_16x16x32_bf16 v[88:91], v[8:11], v[8:11], 0
  ds_read_b64 v[22:23], v7 offset:3072
  ds_read_b64 v[36:37], v6 offset:3328
  s_waitcnt lgkmcnt(11)
  v_mfma_f32_16x16x32_bf16 v[96:99], v[24:27], v[24:27], 0
  ds_read_b64 v[38:39], v7 offset:3328
  ds_read_b128 v[108:111], v0 offset:1024
  v_mfma_f32_16x16x32_bf16 v[92:95], v[8:11], v[72:75], 0
  ds_read_b128 v[112:115], v0 offset:2048
  ds_read_b128 v[116:119], v0 offset:3072
  v_mfma_f32_16x16x32_bf16 v[100:103], v[24:27], v[72:75], 0
  s_waitcnt lgkmcnt(13)
  v_mfma_f32_16x16x32_bf16 v[88:91], v[12:15], v[12:15], v[88:91]
  s_waitcnt lgkmcnt(11)
  v_mfma_f32_16x16x32_bf16 v[96:99], v[28:31], v[28:31], v[96:99]
  v_mfma_f32_16x16x32_bf16 v[92:95], v[12:15], v[76:79], v[92:95]
  v_mfma_f32_16x16x32_bf16 v[100:103], v[28:31], v[76:79], v[100:103]
  s_waitcnt lgkmcnt(9)
  v_mfma_f32_16x16x32_bf16 v[88:91], v[16:19], v[16:19], v[88:91]
  s_waitcnt lgkmcnt(7)
  v_mfma_f32_16x16x32_bf16 v[96:99], v[32:35], v[32:35], v[96:99]
  v_mfma_f32_16x16x32_bf16 v[92:95], v[16:19], v[80:83], v[92:95]
  v_mfma_f32_16x16x32_bf16 v[100:103], v[32:35], v[80:83], v[100:103]
  s_waitcnt lgkmcnt(5)
  v_mfma_f32_16x16x32_bf16 v[88:91], v[20:23], v[20:23], v[88:91]
  s_waitcnt lgkmcnt(3)
  v_mfma_f32_16x16x32_bf16 v[96:99], v[36:39], v[36:39], v[96:99]
  v_mfma_f32_16x16x32_bf16 v[92:95], v[20:23], v[84:87], v[92:95]
  s_nop 4
  v_cndmask_b32 v88, v88, v89, s[30:31]
  v_cndmask_b32 v90, v90, v91, s[30:31]
  v_mfma_f32_16x16x32_bf16 v[100:103], v[36:39], v[84:87], v[100:103]
  v_cndmask_b32 v6, v88, v90, s[32:33]
  v_cndmask_b32 v96, v96, v97, s[30:31]
  v_mfma_f32_16x16x32_bf16 v[72:75], v[104:107], v[8:11], 0
  v_cndmask_b32 v88, v92, v93, s[30:31]
  v_cndmask_b32 v89, v94, v95, s[30:31]
  v_mfma_f32_16x16x32_bf16 v[76:79], v[104:107], v[24:27], 0
  ds_read_b128 v[104:107], v0 offset:4096
  v_cndmask_b32 v4, v88, v89, s[32:33]
  s_waitcnt lgkmcnt(3)
  v_mfma_f32_16x16x32_bf16 v[72:75], v[108:111], v[12:15], v[72:75]
  v_cvt_pk_bf16_f32 v92, v92, v93
  v_cvt_pk_bf16_f32 v93, v94, v95
  v_mfma_f32_16x16x32_bf16 v[76:79], v[108:111], v[28:31], v[76:79]
  ds_read_b128 v[108:111], v0 offset:5120
  v_mov_b32_dpp v6, v6 row_shr:4 row_mask:0x5 bank_mask:0xa
  s_waitcnt lgkmcnt(3)
  v_mfma_f32_16x16x32_bf16 v[72:75], v[112:115], v[16:19], v[72:75]
  v_fma_f32 v7, v4, v4, s21
  v_mov_b32_dpp v6, v6 row_shl:4 row_mask:0xa bank_mask:0x5
  v_mfma_f32_16x16x32_bf16 v[76:79], v[112:115], v[32:35], v[76:79]
  ds_read_b128 v[112:115], v0 offset:6144
  v_mov_b32_dpp v7, v7 row_shr:4 row_mask:0xf bank_mask:0x2
  s_waitcnt lgkmcnt(3)
  v_mfma_f32_16x16x32_bf16 v[72:75], v[116:119], v[20:23], v[72:75]
  v_mov_b32_dpp v7, v7 row_shr:8 row_mask:0xf bank_mask:0xc
  v_fma_f32 v6, v7, s22, v6
  v_mfma_f32_16x16x32_bf16 v[76:79], v[116:119], v[36:39], v[76:79]
  ds_read_b128 v[116:119], v0 offset:7168
  v_max_f32 v6, s23, v6
  v_rsq_f32 v94, v6
  s_waitcnt lgkmcnt(3)
  v_mfma_f32_16x16x32_bf16 v[80:83], v[104:107], v[8:11], 0
  v_mov_b32 v6, v94
  v_mov_b32 v7, v94
  v_mfma_f32_16x16x32_bf16 v[84:87], v[104:107], v[24:27], 0
  ds_read_b128 v[104:107], v0 offset:8192
  v_permlane16_swap_b32 v6, v7
  s_waitcnt lgkmcnt(3)
  v_mfma_f32_16x16x32_bf16 v[80:83], v[108:111], v[12:15], v[80:83]
  v_cndmask_b32 v95, v6, v7, s[34:35]
  v_cndmask_b32 v98, v98, v99, s[30:31]
  v_mfma_f32_16x16x32_bf16 v[84:87], v[108:111], v[28:31], v[84:87]
  ds_read_b128 v[108:111], v0 offset:9216
  v_cndmask_b32 v126, v96, v98, s[32:33]
  s_waitcnt lgkmcnt(3)
  v_mfma_f32_16x16x32_bf16 v[80:83], v[112:115], v[16:19], v[80:83]
  v_cndmask_b32 v96, v100, v101, s[30:31]
  v_cndmask_b32 v97, v102, v103, s[30:31]
  v_mfma_f32_16x16x32_bf16 v[84:87], v[112:115], v[32:35], v[84:87]
  ds_read_b128 v[112:115], v0 offset:10240
  v_cndmask_b32 v5, v96, v97, s[32:33]
  s_waitcnt lgkmcnt(3)
  v_mfma_f32_16x16x32_bf16 v[80:83], v[116:119], v[20:23], v[80:83]
  v_cvt_pk_bf16_f32 v100, v100, v101
  v_cvt_pk_bf16_f32 v101, v102, v103
  v_mfma_f32_16x16x32_bf16 v[84:87], v[116:119], v[36:39], v[84:87]
  ds_read_b128 v[116:119], v0 offset:11264
  v_mov_b32_dpp v126, v126 row_shr:4 row_mask:0x5 bank_mask:0xa
  v_fma_f32 v127, v5, v5, s21
  v_cvt_pk_bf16_f32 v40, v72, v73
  v_mov_b32_dpp v126, v126 row_shl:4 row_mask:0xa bank_mask:0x5
  v_mov_b32_dpp v127, v127 row_shr:4 row_mask:0xf bank_mask:0x2
  v_cvt_pk_bf16_f32 v41, v74, v75
  s_waitcnt lgkmcnt(3)
  v_mfma_f32_16x16x32_bf16 v[72:75], v[104:107], v[8:11], 0
  v_mov_b32_dpp v127, v127 row_shr:8 row_mask:0xf bank_mask:0xc
  v_fma_f32 v126, v127, s22, v126
  v_max_f32 v126, s23, v126
  s_waitcnt lgkmcnt(2)
  v_mfma_f32_16x16x32_bf16 v[72:75], v[108:111], v[12:15], v[72:75]
  v_rsq_f32 v102, v126
  s_nop 0
  v_mov_b32 v126, v102
  v_mov_b32 v127, v102
  v_cvt_pk_bf16_f32 v56, v76, v77
  v_cvt_pk_bf16_f32 v57, v78, v79
  v_mfma_f32_16x16x32_bf16 v[76:79], v[104:107], v[24:27], 0
  ds_read_b128 v[104:107], v0 offset:12288
  v_permlane16_swap_b32 v126, v127
  v_mfma_f32_16x16x32_bf16 v[76:79], v[108:111], v[28:31], v[76:79]
  ds_read_b128 v[108:111], v0 offset:13312
  v_cndmask_b32 v103, v126, v127, s[34:35]
  s_waitcnt lgkmcnt(3)
  v_mfma_f32_16x16x32_bf16 v[72:75], v[112:115], v[16:19], v[72:75]
  v_cvt_pk_bf16_f32 v42, v80, v81
  v_cvt_pk_bf16_f32 v43, v82, v83
  v_mfma_f32_16x16x32_bf16 v[76:79], v[112:115], v[32:35], v[76:79]
  ds_read_b128 v[112:115], v0 offset:14336
  v_cvt_pk_bf16_f32 v58, v84, v85
  v_mfma_f32_16x16x32_bf16 v[88:91], v[8:11], v[40:43], 0
  v_cvt_pk_bf16_f32 v59, v86, v87
  s_waitcnt lgkmcnt(3)
  v_mfma_f32_16x16x32_bf16 v[72:75], v[116:119], v[20:23], v[72:75]
  v_mfma_f32_16x16x32_bf16 v[96:99], v[24:27], v[56:59], 0
  v_mfma_f32_16x16x32_bf16 v[76:79], v[116:119], v[36:39], v[76:79]
  ds_read_b128 v[116:119], v0 offset:15360
  s_nop 4
  v_cvt_pk_bf16_f32 v44, v72, v73
  s_waitcnt lgkmcnt(3)
  v_mfma_f32_16x16x32_bf16 v[80:83], v[104:107], v[8:11], 0
  v_cvt_pk_bf16_f32 v45, v74, v75
  v_mfma_f32_16x16x32_bf16 v[84:87], v[104:107], v[24:27], 0
  ds_read_b128 v[104:107], v0 offset:16384
  v_cvt_pk_bf16_f32 v60, v76, v77
  s_waitcnt lgkmcnt(3)
  v_mfma_f32_16x16x32_bf16 v[80:83], v[108:111], v[12:15], v[80:83]
  v_cvt_pk_bf16_f32 v61, v78, v79
  v_mfma_f32_16x16x32_bf16 v[84:87], v[108:111], v[28:31], v[84:87]
  ds_read_b128 v[108:111], v0 offset:17408
  s_waitcnt lgkmcnt(3)
  v_mfma_f32_16x16x32_bf16 v[80:83], v[112:115], v[16:19], v[80:83]
  v_mfma_f32_16x16x32_bf16 v[84:87], v[112:115], v[32:35], v[84:87]
  ds_read_b128 v[112:115], v0 offset:18432
  s_waitcnt lgkmcnt(3)
  v_mfma_f32_16x16x32_bf16 v[80:83], v[116:119], v[20:23], v[80:83]
  v_mfma_f32_16x16x32_bf16 v[84:87], v[116:119], v[36:39], v[84:87]
  ds_read_b128 v[116:119], v0 offset:19456
  s_waitcnt lgkmcnt(3)
  v_mfma_f32_16x16x32_bf16 v[72:75], v[104:107], v[8:11], 0
  s_nop 3
  v_cvt_pk_bf16_f32 v46, v80, v81
  v_cvt_pk_bf16_f32 v47, v82, v83
  v_mfma_f32_16x16x32_bf16 v[76:79], v[104:107], v[24:27], 0
  ds_read_b128 v[104:107], v0 offset:20480
  v_cvt_pk_bf16_f32 v62, v84, v85
  v_mfma_f32_16x16x32_bf16 v[88:91], v[12:15], v[44:47], v[88:91]
  v_cvt_pk_bf16_f32 v63, v86, v87
  s_waitcnt lgkmcnt(3)
  v_mfma_f32_16x16x32_bf16 v[72:75], v[108:111], v[12:15], v[72:75]
  v_mfma_f32_16x16x32_bf16 v[96:99], v[28:31], v[60:63], v[96:99]
  v_mfma_f32_16x16x32_bf16 v[76:79], v[108:111], v[28:31], v[76:79]
  ds_read_b128 v[108:111], v0 offset:21504
  s_waitcnt lgkmcnt(3)
  v_mfma_f32_16x16x32_bf16 v[72:75], v[112:115], v[16:19], v[72:75]
  v_mfma_f32_16x16x32_bf16 v[76:79], v[112:115], v[32:35], v[76:79]
  ds_read_b128 v[112:115], v0 offset:22528
  s_waitcnt lgkmcnt(3)
  v_mfma_f32_16x16x32_bf16 v[72:75], v[116:119], v[20:23], v[72:75]
  v_mfma_f32_16x16x32_bf16 v[76:79], v[116:119], v[36:39], v[76:79]
  ds_read_b128 v[116:119], v0 offset:23552
  s_waitcnt lgkmcnt(3)
  v_mfma_f32_16x16x32_bf16 v[80:83], v[104:107], v[8:11], 0
  s_nop 3
  v_cvt_pk_bf16_f32 v48, v72, v73
  v_cvt_pk_bf16_f32 v49, v74, v75
  v_mfma_f32_16x16x32_bf16 v[84:87], v[104:107], v[24:27], 0
  ds_read_b128 v[104:107], v0 offset:24576
  v_cvt_pk_bf16_f32 v64, v76, v77
  v_cvt_pk_bf16_f32 v65, v78, v79
  s_waitcnt lgkmcnt(3)
  v_mfma_f32_16x16x32_bf16 v[80:83], v[108:111], v[12:15], v[80:83]
  v_mfma_f32_16x16x32_bf16 v[84:87], v[108:111], v[28:31], v[84:87]
  ds_read_b128 v[108:111], v0 offset:25600
  s_waitcnt lgkmcnt(3)
  v_mfma_f32_16x16x32_bf16 v[80:83], v[112:115], v[16:19], v[80:83]
  v_mfma_f32_16x16x32_bf16 v[84:87], v[112:115], v[32:35], v[84:87]
  ds_read_b128 v[112:115], v0 offset:26624
  s_waitcnt lgkmcnt(3)
  v_mfma_f32_16x16x32_bf16 v[80:83], v[116:119], v[20:23], v[80:83]
  v_mfma_f32_16x16x32_bf16 v[84:87], v[116:119], v[36:39], v[84:87]
  ds_read_b128 v[116:119], v0 offset:27648
  s_waitcnt lgkmcnt(3)
  v_mfma_f32_16x16x32_bf16 v[72:75], v[104:107], v[8:11], 0
  s_nop 3
  v_cvt_pk_bf16_f32 v50, v80, v81
  v_cvt_pk_bf16_f32 v51, v82, v83
  v_mfma_f32_16x16x32_bf16 v[76:79], v[104:107], v[24:27], 0
  ds_read_b128 v[104:107], v0 offset:28672
  v_cvt_pk_bf16_f32 v66, v84, v85
  v_mfma_f32_16x16x32_bf16 v[88:91], v[16:19], v[48:51], v[88:91]
  v_cvt_pk_bf16_f32 v67, v86, v87
  s_waitcnt lgkmcnt(3)
  v_mfma_f32_16x16x32_bf16 v[72:75], v[108:111], v[12:15], v[72:75]
  v_mfma_f32_16x16x32_bf16 v[96:99], v[32:35], v[64:67], v[96:99]
  v_mfma_f32_16x16x32_bf16 v[76:79], v[108:111], v[28:31], v[76:79]
  ds_read_b128 v[108:111], v0 offset:29696
  s_waitcnt lgkmcnt(3)
  v_mfma_f32_16x16x32_bf16 v[72:75], v[112:115], v[16:19], v[72:75]
  v_mfma_f32_16x16x32_bf16 v[76:79], v[112:115], v[32:35], v[76:79]
  ds_read_b128 v[112:115], v0 offset:30720
  s_waitcnt lgkmcnt(3)
  v_mfma_f32_16x16x32_bf16 v[72:75], v[116:119], v[20:23], v[72:75]
  v_mfma_f32_16x16x32_bf16 v[76:79], v[116:119], v[36:39], v[76:79]
  ds_read_b32 v120, v0
  ds_read_b128 v[116:119], v0 offset:31744
  s_waitcnt lgkmcnt(4)
  v_mfma_f32_16x16x32_bf16 v[80:83], v[104:107], v[8:11], 0
  s_nop 2
  v_cvt_pk_bf16_f32 v52, v72, v73
  v_cvt_pk_bf16_f32 v53, v74, v75
  v_mfma_f32_16x16x32_bf16 v[84:87], v[104:107], v[24:27], 0
  v_cvt_pk_bf16_f32 v68, v76, v77
  v_cvt_pk_bf16_f32 v69, v78, v79
  s_waitcnt lgkmcnt(3)
  v_mfma_f32_16x16x32_bf16 v[80:83], v[108:111], v[12:15], v[80:83]
  v_mfma_f32_16x16x32_bf16 v[84:87], v[108:111], v[28:31], v[84:87]
  s_waitcnt lgkmcnt(2)
  v_mfma_f32_16x16x32_bf16 v[80:83], v[112:115], v[16:19], v[80:83]
  v_mfma_f32_16x16x32_bf16 v[84:87], v[112:115], v[32:35], v[84:87]
  s_waitcnt lgkmcnt(0)
  v_mfma_f32_16x16x32_bf16 v[80:83], v[116:119], v[20:23], v[80:83]
  v_mfma_f32_16x16x32_bf16 v[84:87], v[116:119], v[36:39], v[84:87]
  v_readfirstlane_b32 s40, v120
  s_bitcmp1_b32 s40, 10
  s_cbranch_scc0 K4_PW
K4_P1:
  ds_read_b128 v[104:107], v0 offset:32768
  ds_read_b128 v[108:111], v0 offset:33792
  ds_read_b128 v[112:115], v0 offset:34816
  ds_read_b128 v[116:119], v0 offset:35840
  v_cvt_pk_bf16_f32 v54, v80, v81
  v_cvt_pk_bf16_f32 v55, v82, v83
  v_cvt_pk_bf16_f32 v70, v84, v85
  v_cvt_pk_bf16_f32 v71, v86, v87
  v_mfma_f32_16x16x32_bf16 v[88:91], v[20:23], v[52:55], v[88:91]
  s_nop 0
  v_mfma_f32_16x16x32_bf16 v[96:99], v[36:39], v[68:71], v[96:99]
  s_nop 5
  v_mul_f32_dpp v88, v94, v88 quad_perm:[0,0,0,0] row_mask:0xf bank_mask:0xf
  v_mul_f32_dpp v89, v94, v89 quad_perm:[1,1,1,1] row_mask:0xf bank_mask:0xf
  v_mul_f32_dpp v90, v94, v90 quad_perm:[2,2,2,2] row_mask:0xf bank_mask:0xf
  v_mul_f32_dpp v91, v94, v91 quad_perm:[3,3,3,3] row_mask:0xf bank_mask:0xf
  v_max3_f32 v6, v88, v89, v90
  v_max_f32 v6, v6, v91
  v_mov_b32 v7, v6
  v_mul_f32_dpp v96, v102, v96 quad_perm:[0,0,0,0] row_mask:0xf bank_mask:0xf
  v_mul_f32_dpp v97, v102, v97 quad_perm:[1,1,1,1] row_mask:0xf bank_mask:0xf
  v_permlane16_swap_b32 v7, v6
  v_max_f32 v6, v6, v7
  s_waitcnt lgkmcnt(3)
  v_mfma_f32_16x16x32_bf16 v[40:43], v[8:11], v[104:107], 0
  v_mul_f32 v6, -v95, v6
  v_fma_f32 v88, v88, v95, v6
  v_mfma_f32_16x16x32_bf16 v[44:47], v[24:27], v[104:107], 0
  ds_read_b128 v[104:107], v0 offset:36864
  v_fma_f32 v89, v89, v95, v6
  s_waitcnt lgkmcnt(3)
  v_mfma_f32_16x16x32_bf16 v[40:43], v[12:15], v[108:111], v[40:43]
  v_fma_f32 v90, v90, v95, v6
  v_fma_f32 v91, v91, v95, v6
  v_mfma_f32_16x16x32_bf16 v[44:47], v[28:31], v[108:111], v[44:47]
  ds_read_b128 v[108:111], v0 offset:37888
  v_exp_f32 v88, v88
  s_waitcnt lgkmcnt(3)
  v_mfma_f32_16x16x32_bf16 v[40:43], v[16:19], v[112:115], v[40:43]
  v_exp_f32 v89, v89
  v_mfma_f32_16x16x32_bf16 v[44:47], v[32:35], v[112:115], v[44:47]
  ds_read_b128 v[112:115], v0 offset:38912
  v_exp_f32 v90, v90
  s_waitcnt lgkmcnt(3)
  v_mfma_f32_16x16x32_bf16 v[40:43], v[20:23], v[116:119], v[40:43]
  v_exp_f32 v91, v91
  v_mfma_f32_16x16x32_bf16 v[44:47], v[36:39], v[116:119], v[44:47]
  ds_read_b128 v[116:119], v0 offset:39936
  v_add_f32 v6, v88, v89
  s_waitcnt lgkmcnt(3)
  v_mfma_f32_16x16x32_bf16 v[48:51], v[8:11], v[104:107], 0
  v_add_f32 v7, v90, v91
  v_add_f32 v6, v6, v7
  v_mfma_f32_16x16x32_bf16 v[52:55], v[24:27], v[104:107], 0
  ds_read_b128 v[104:107], v0 offset:40960
  v_mov_b32 v7, v6
  s_waitcnt lgkmcnt(3)
  v_mfma_f32_16x16x32_bf16 v[48:51], v[12:15], v[108:111], v[48:51]
  v_permlane16_swap_b32 v7, v6
  v_add_f32 v6, v6, v7
  v_mfma_f32_16x16x32_bf16 v[52:55], v[28:31], v[108:111], v[52:55]
  ds_read_b128 v[108:111], v0 offset:41984
  v_rcp_f32 v6, v6
  s_waitcnt lgkmcnt(3)
  v_mfma_f32_16x16x32_bf16 v[48:51], v[16:19], v[112:115], v[48:51]
  v_mul_f32_dpp v88, v94, v88 quad_perm:[0,0,0,0] row_mask:0xf bank_mask:0xf
  v_mul_f32_dpp v89, v94, v89 quad_perm:[1,1,1,1] row_mask:0xf bank_mask:0xf
  v_mfma_f32_16x16x32_bf16 v[52:55], v[32:35], v[112:115], v[52:55]
  ds_read_b128 v[112:115], v0 offset:43008
  v_mul_f32_dpp v90, v94, v90 quad_perm:[2,2,2,2] row_mask:0xf bank_mask:0xf
  v_mul_f32_dpp v91, v94, v91 quad_perm:[3,3,3,3] row_mask:0xf bank_mask:0xf
  s_waitcnt lgkmcnt(3)
  v_mfma_f32_16x16x32_bf16 v[48:51], v[20:23], v[116:119], v[48:51]
  v_mul_f32 v88, v88, v6
  v_mul_f32 v89, v89, v6
  v_mfma_f32_16x16x32_bf16 v[52:55], v[36:39], v[116:119], v[52:55]
  ds_read_b128 v[116:119], v0 offset:44032
  v_mul_f32 v90, v90, v6
  s_waitcnt lgkmcnt(3)
  v_mfma_f32_16x16x32_bf16 v[56:59], v[8:11], v[104:107], 0
  v_mul_f32 v91, v91, v6
  v_cvt_pk_bf16_f32 v88, v88, v89
  v_mfma_f32_16x16x32_bf16 v[60:63], v[24:27], v[104:107], 0
  ds_read_b128 v[104:107], v0 offset:45056
  v_cvt_pk_bf16_f32 v89, v90, v91
  s_waitcnt lgkmcnt(3)
  v_mfma_f32_16x16x32_bf16 v[56:59], v[12:15], v[108:111], v[56:59]
  v_cndmask_b32 v120, 0, v88, s[36:37]
  v_cndmask_b32 v121, 0, v89, s[36:37]
  v_mfma_f32_16x16x32_bf16 v[60:63], v[28:31], v[108:111], v[60:63]
  ds_read_b128 v[108:111], v0 offset:46080
  v_mul_f32_dpp v98, v102, v98 quad_perm:[2,2,2,2] row_mask:0xf bank_mask:0xf
  v_mfma_f32_16x16x16_bf16 v[88:91], v[120:121], v[92:93], 0
  v_mul_f32_dpp v99, v102, v99 quad_perm:[3,3,3,3] row_mask:0xf bank_mask:0xf
  v_max3_f32 v126, v96, v97, v98
  s_waitcnt lgkmcnt(3)
  v_mfma_f32_16x16x32_bf16 v[56:59], v[16:19], v[112:115], v[56:59]
  v_max_f32 v126, v126, v99
  v_mov_b32 v127, v126
  v_mfma_f32_16x16x32_bf16 v[60:63], v[32:35], v[112:115], v[60:63]
  ds_read_b128 v[112:115], v0 offset:47104
  v_cndmask_b32 v88, v88, v89, s[30:31]
  s_waitcnt lgkmcnt(3)
  v_mfma_f32_16x16x32_bf16 v[56:59], v[20:23], v[116:119], v[56:59]
  v_cndmask_b32 v90, v90, v91, s[30:31]
  v_cndmask_b32 v6, v88, v90, s[32:33]
  v_mfma_f32_16x16x32_bf16 v[60:63], v[36:39], v[116:119], v[60:63]
  ds_read_b128 v[116:119], v0 offset:48128
  v_add_f32_dpp v4, v4, v6 row_ror:8 row_mask:0xf bank_mask:0xf
  s_waitcnt lgkmcnt(3)
  v_mfma_f32_16x16x32_bf16 v[64:67], v[8:11], v[104:107], 0
  v_permlane16_swap_b32 v127, v126
  v_max_f32 v126, v126, v127
  v_mfma_f32_16x16x32_bf16 v[68:71], v[24:27], v[104:107], 0
  ds_read_b128 v[104:107], v0 offset:49152
  v_mul_f32 v126, -v103, v126
  s_waitcnt lgkmcnt(3)
  v_mfma_f32_16x16x32_bf16 v[64:67], v[12:15], v[108:111], v[64:67]
  v_fma_f32 v96, v96, v103, v126
  v_fma_f32 v97, v97, v103, v126
  v_mfma_f32_16x16x32_bf16 v[68:71], v[28:31], v[108:111], v[68:71]
  ds_read_b128 v[108:111], v0 offset:50176
  v_fma_f32 v98, v98, v103, v126
  v_fma_f32 v99, v99, v103, v126
  v_exp_f32 v96, v96
  s_waitcnt lgkmcnt(3)
  v_mfma_f32_16x16x32_bf16 v[64:67], v[16:19], v[112:115], v[64:67]
  v_exp_f32 v97, v97
  v_mfma_f32_16x16x32_bf16 v[68:71], v[32:35], v[112:115], v[68:71]
  ds_read_b128 v[112:115], v0 offset:51200
  v_exp_f32 v98, v98
  s_waitcnt lgkmcnt(3)
  v_mfma_f32_16x16x32_bf16 v[64:67], v[20:23], v[116:119], v[64:67]
  v_exp_f32 v99, v99
  v_mfma_f32_16x16x32_bf16 v[68:71], v[36:39], v[116:119], v[68:71]
  ds_read_b128 v[116:119], v0 offset:52224
  v_add_f32 v126, v96, v97
  s_waitcnt lgkmcnt(3)
  v_mfma_f32_16x16x32_bf16 v[72:75], v[8:11], v[104:107], 0
  v_add_f32 v127, v98, v99
  v_add_f32 v126, v126, v127
  v_mfma_f32_16x16x32_bf16 v[76:79], v[24:27], v[104:107], 0
  ds_read_b128 v[104:107], v0 offset:53248
  v_mov_b32 v127, v126
  s_waitcnt lgkmcnt(3)
  v_mfma_f32_16x16x32_bf16 v[72:75], v[12:15], v[108:111], v[72:75]
  v_permlane16_swap_b32 v127, v126
  v_add_f32 v126, v126, v127
  v_mfma_f32_16x16x32_bf16 v[76:79], v[28:31], v[108:111], v[76:79]
  ds_read_b128 v[108:111], v0 offset:54272
  v_rcp_f32 v126, v126
  s_waitcnt lgkmcnt(3)
  v_mfma_f32_16x16x32_bf16 v[72:75], v[16:19], v[112:115], v[72:75]
  v_mul_f32_dpp v96, v102, v96 quad_perm:[0,0,0,0] row_mask:0xf bank_mask:0xf
  v_mul_f32_dpp v97, v102, v97 quad_perm:[1,1,1,1] row_mask:0xf bank_mask:0xf
  v_mfma_f32_16x16x32_bf16 v[76:79], v[32:35], v[112:115], v[76:79]
  ds_read_b128 v[112:115], v0 offset:55296
  v_mul_f32_dpp v98, v102, v98 quad_perm:[2,2,2,2] row_mask:0xf bank_mask:0xf
  v_mul_f32_dpp v99, v102, v99 quad_perm:[3,3,3,3] row_mask:0xf bank_mask:0xf
  s_waitcnt lgkmcnt(3)
  v_mfma_f32_16x16x32_bf16 v[72:75], v[20:23], v[116:119], v[72:75]
  v_mul_f32 v96, v96, v126
  v_mul_f32 v97, v97, v126
  v_mfma_f32_16x16x32_bf16 v[76:79], v[36:39], v[116:119], v[76:79]
  ds_read_b128 v[116:119], v0 offset:56320
  v_mul_f32 v98, v98, v126
  s_waitcnt lgkmcnt(3)
  v_mfma_f32_16x16x32_bf16 v[80:83], v[8:11], v[104:107], 0
  v_mul_f32 v99, v99, v126
  v_cvt_pk_bf16_f32 v96, v96, v97
  v_mfma_f32_16x16x32_bf16 v[84:87], v[24:27], v[104:107], 0
  ds_read_b128 v[104:107], v0 offset:57344
  v_cvt_pk_bf16_f32 v97, v98, v99
  s_waitcnt lgkmcnt(3)
  v_mfma_f32_16x16x32_bf16 v[80:83], v[12:15], v[108:111], v[80:83]
  v_cndmask_b32 v124, 0, v96, s[36:37]
  v_cndmask_b32 v125, 0, v97, s[36:37]
  v_mfma_f32_16x16x32_bf16 v[84:87], v[28:31], v[108:111], v[84:87]
  ds_read_b128 v[108:111], v0 offset:58368
  v_cvt_pk_bf16_f32 v40, v40, v41
  v_mfma_f32_16x16x16_bf16 v[96:99], v[124:125], v[100:101], 0
  v_cvt_pk_bf16_f32 v41, v42, v43
  ds_read_b64_tr_b16 v[42:43], v1 offset:0
  s_waitcnt lgkmcnt(4)
  v_mfma_f32_16x16x32_bf16 v[80:83], v[16:19], v[112:115], v[80:83]
  v_cvt_pk_bf16_f32 v47, v46, v47
  v_cvt_pk_bf16_f32 v46, v44, v45
  v_mfma_f32_16x16x32_bf16 v[84:87], v[32:35], v[112:115], v[84:87]
  ds_read_b64_tr_b16 v[44:45], v1 offset:256
  ds_read_b128 v[112:115], v0 offset:59392
  s_waitcnt lgkmcnt(5)
  v_mfma_f32_16x16x32_bf16 v[80:83], v[20:23], v[116:119], v[80:83]
  v_cndmask_b32 v96, v96, v97, s[30:31]
  v_cndmask_b32 v98, v98, v99, s[30:31]
  v_mfma_f32_16x16x32_bf16 v[84:87], v[36:39], v[116:119], v[84:87]
  ds_read_b128 v[116:119], v0 offset:60416
  v_cndmask_b32 v126, v96, v98, s[32:33]
  s_waitcnt lgkmcnt(5)
  v_mfma_f32_16x16x32_bf16 v[88:91], v[8:11], v[104:107], 0
  v_add_f32_dpp v5, v5, v126 row_ror:8 row_mask:0xf bank_mask:0xf
  v_cvt_pk_bf16_f32 v48, v48, v49
  v_mfma_f32_16x16x32_bf16 v[92:95], v[24:27], v[104:107], 0
  ds_read_b128 v[104:107], v0 offset:61440
  v_cvt_pk_bf16_f32 v49, v50, v51
  s_waitcnt lgkmcnt(5)
  v_mfma_f32_16x16x32_bf16 v[88:91], v[12:15], v[108:111], v[88:91]
  ds_read_b64_tr_b16 v[50:51], v2 offset:0
  v_cvt_pk_bf16_f32 v55, v54, v55
  s_waitcnt lgkmcnt(5)
  v_mfma_f32_16x16x32_bf16 v[40:43], v[120:123], v[40:43], 0
  v_cvt_pk_bf16_f32 v54, v52, v53
  ds_read_b64_tr_b16 v[52:53], v2 offset:256
  v_mfma_f32_16x16x32_bf16 v[92:95], v[28:31], v[108:111], v[92:95]
  ds_read_b128 v[108:111], v0 offset:62464
  v_cvt_pk_bf16_f32 v56, v56, v57
  s_waitcnt lgkmcnt(6)
  v_mfma_f32_16x16x32_bf16 v[44:47], v[122:125], v[44:47], 0
  v_cvt_pk_bf16_f32 v57, v58, v59
  ds_read_b64_tr_b16 v[58:59], v1 offset:1024
  s_waitcnt lgkmcnt(6)
  v_mfma_f32_16x16x32_bf16 v[88:91], v[16:19], v[112:115], v[88:91]
  v_cvt_pk_bf16_f32 v63, v62, v63
  v_cvt_pk_bf16_f32 v62, v60, v61
  v_mfma_f32_16x16x32_bf16 v[92:95], v[32:35], v[112:115], v[92:95]
  ds_read_b64_tr_b16 v[60:61], v1 offset:1280
  ds_read_b128 v[112:115], v0 offset:63488
  s_waitcnt lgkmcnt(7)
  v_mfma_f32_16x16x32_bf16 v[88:91], v[20:23], v[116:119], v[88:91]
  v_cvt_pk_bf16_f32 v64, v64, v65
  v_cvt_pk_bf16_f32 v65, v66, v67
  v_mfma_f32_16x16x32_bf16 v[92:95], v[36:39], v[116:119], v[92:95]
  ds_read_b64_tr_b16 v[66:67], v2 offset:1024
  ds_read_b128 v[116:119], v0 offset:64512
  s_waitcnt lgkmcnt(7)
  v_mfma_f32_16x16x32_bf16 v[48:51], v[120:123], v[48:51], 0
  v_cvt_pk_bf16_f32 v71, v70, v71
  v_cvt_pk_bf16_f32 v70, v68, v69
  s_waitcnt lgkmcnt(6)
  v_mfma_f32_16x16x32_bf16 v[52:55], v[122:125], v[52:55], 0
  ds_read_b64_tr_b16 v[68:69], v2 offset:1280
  v_cvt_pk_bf16_f32 v72, v72, v73
  v_mfma_f32_16x16x32_bf16 v[96:99], v[8:11], v[104:107], 0
  v_cvt_pk_bf16_f32 v73, v74, v75
  ds_read_b64_tr_b16 v[74:75], v1 offset:2048
  s_waitcnt lgkmcnt(6)
  v_mfma_f32_16x16x32_bf16 v[56:59], v[120:123], v[56:59], 0
  v_cvt_pk_bf16_f32 v79, v78, v79
  v_cvt_pk_bf16_f32 v78, v76, v77
  v_mfma_f32_16x16x32_bf16 v[100:103], v[24:27], v[104:107], 0
  ds_read_b64_tr_b16 v[76:77], v1 offset:2304
  v_cvt_pk_bf16_f32 v80, v80, v81
  s_waitcnt lgkmcnt(6)
  v_mfma_f32_16x16x32_bf16 v[60:63], v[122:125], v[60:63], 0
  v_cvt_pk_bf16_f32 v81, v82, v83
  ds_read_b64_tr_b16 v[82:83], v2 offset:2048
  v_mfma_f32_16x16x32_bf16 v[96:99], v[12:15], v[108:111], v[96:99]
  v_cvt_pk_bf16_f32 v87, v86, v87
  v_cvt_pk_bf16_f32 v86, v84, v85
  s_waitcnt lgkmcnt(5)
  v_mfma_f32_16x16x32_bf16 v[64:67], v[120:123], v[64:67], 0
  ds_read_b64_tr_b16 v[84:85], v2 offset:2304
  v_cvt_pk_bf16_f32 v88, v88, v89
  v_mfma_f32_16x16x32_bf16 v[100:103], v[28:31], v[108:111], v[100:103]
  v_cvt_pk_bf16_f32 v89, v90, v91
  ds_read_b64_tr_b16 v[90:91], v1 offset:3072
  s_waitcnt lgkmcnt(5)
  v_mfma_f32_16x16x32_bf16 v[68:71], v[122:125], v[68:71], 0
  v_cvt_pk_bf16_f32 v95, v94, v95
  v_cvt_pk_bf16_f32 v94, v92, v93
  s_waitcnt lgkmcnt(4)
  v_mfma_f32_16x16x32_bf16 v[72:75], v[120:123], v[72:75], 0
  ds_read_b64_tr_b16 v[92:93], v1 offset:3328
  v_mul_f32 v8, v40, v40
  v_mfma_f32_16x16x32_bf16 v[96:99], v[16:19], v[112:115], v[96:99]
  v_mul_f32 v9, v41, v41
  v_mul_f32 v10, v42, v42
  s_waitcnt lgkmcnt(4)
  v_mfma_f32_16x16x32_bf16 v[76:79], v[122:125], v[76:79], 0
  v_mul_f32 v11, v43, v43
  v_mul_f32 v24, v44, v44
  s_waitcnt lgkmcnt(3)
  v_mfma_f32_16x16x32_bf16 v[80:83], v[120:123], v[80:83], 0
  v_mul_f32 v25, v45, v45
  v_mul_f32 v26, v46, v46
  v_mfma_f32_16x16x32_bf16 v[100:103], v[32:35], v[112:115], v[100:103]
  v_mul_f32 v27, v47, v47
  v_fmac_f32 v8, v48, v48
  s_waitcnt lgkmcnt(2)
  v_mfma_f32_16x16x32_bf16 v[84:87], v[122:125], v[84:87], 0
  v_fmac_f32 v9, v49, v49
  v_fmac_f32 v10, v50, v50
  s_waitcnt lgkmcnt(1)
  v_mfma_f32_16x16x32_bf16 v[88:91], v[120:123], v[88:91], 0
  v_fmac_f32 v11, v51, v51
  v_fmac_f32 v24, v52, v52
  v_mfma_f32_16x16x32_bf16 v[96:99], v[20:23], v[116:119], v[96:99]
  v_fmac_f32 v25, v53, v53
  v_fmac_f32 v26, v54, v54
  s_waitcnt lgkmcnt(0)
  v_mfma_f32_16x16x32_bf16 v[92:95], v[122:125], v[92:95], 0
  v_fmac_f32 v27, v55, v55
  v_fmac_f32 v8, v56, v56
  v_mfma_f32_16x16x32_bf16 v[100:103], v[36:39], v[116:119], v[100:103]
  s_nop 0
  v_cvt_pk_bf16_f32 v96, v96, v97
  v_cvt_pk_bf16_f32 v97, v98, v99
  ds_read_b64_tr_b16 v[98:99], v2 offset:3072
  s_setprio 0
  v_fmac_f32 v9, v57, v57
  v_fmac_f32 v10, v58, v58
  v_fmac_f32 v11, v59, v59
  v_cvt_pk_bf16_f32 v103, v102, v103
  v_cvt_pk_bf16_f32 v102, v100, v101
  ds_read_b64_tr_b16 v[100:101], v2 offset:3328
  v_fmac_f32 v24, v60, v60
  v_fmac_f32 v25, v61, v61
  v_fmac_f32 v26, v62, v62
  v_fmac_f32 v27, v63, v63
  v_fmac_f32 v8, v64, v64
  v_fmac_f32 v9, v65, v65
  v_fmac_f32 v10, v66, v66
  v_fmac_f32 v11, v67, v67
  v_fmac_f32 v24, v68, v68
  v_fmac_f32 v25, v69, v69
  v_fmac_f32 v26, v70, v70
  v_fmac_f32 v27, v71, v71
  v_fmac_f32 v8, v72, v72
  v_fmac_f32 v9, v73, v73
  v_fmac_f32 v10, v74, v74
  v_fmac_f32 v11, v75, v75
  v_fmac_f32 v24, v76, v76
  v_fmac_f32 v25, v77, v77
  v_fmac_f32 v26, v78, v78
  v_fmac_f32 v27, v79, v79
  s_waitcnt lgkmcnt(1)
  v_mfma_f32_16x16x32_bf16 v[96:99], v[120:123], v[96:99], 0
  v_fmac_f32 v8, v80, v80
  v_fmac_f32 v9, v81, v81
  v_fmac_f32 v10, v82, v82
  v_fmac_f32 v11, v83, v83
  v_fmac_f32 v24, v84, v84
  s_waitcnt lgkmcnt(0)
  v_mfma_f32_16x16x32_bf16 v[100:103], v[122:125], v[100:103], 0
  v_fmac_f32 v25, v85, v85
  v_fmac_f32 v26, v86, v86
  v_fmac_f32 v27, v87, v87
  v_fmac_f32 v8, v88, v88
  v_fmac_f32 v9, v89, v89
  v_fmac_f32 v10, v90, v90
  v_fmac_f32 v11, v91, v91
  v_fmac_f32 v24, v92, v92
  v_fmac_f32 v25, v93, v93
  v_fmac_f32 v26, v94, v94
  v_fmac_f32 v27, v95, v95
  v_fmac_f32 v8, v96, v96
  v_fmac_f32 v9, v97, v97
  v_fmac_f32 v10, v98, v98
  v_fmac_f32 v11, v99, v99
  v_fmac_f32 v24, v100, v100
  v_fmac_f32 v25, v101, v101
  v_fmac_f32 v26, v102, v102
  v_fmac_f32 v27, v103, v103
  v_add_f32_dpp v8, v8, v8 quad_perm:[1,0,3,2] row_mask:0xf bank_mask:0xf
  v_add_f32_dpp v9, v9, v9 quad_perm:[1,0,3,2] row_mask:0xf bank_mask:0xf
  v_add_f32_dpp v10, v10, v10 quad_perm:[1,0,3,2] row_mask:0xf bank_mask:0xf
  v_add_f32_dpp v11, v11, v11 quad_perm:[1,0,3,2] row_mask:0xf bank_mask:0xf
  v_cndmask_b32 v8, v8, v9, s[30:31]
  v_cndmask_b32 v10, v10, v11, s[30:31]
  v_mov_b32_dpp v6, v4 row_ror:4 row_mask:0xf bank_mask:0xf
  v_add_f32_dpp v8, v8, v8 quad_perm:[2,3,0,1] row_mask:0xf bank_mask:0xf
  v_add_f32_dpp v10, v10, v10 quad_perm:[2,3,0,1] row_mask:0xf bank_mask:0xf
  v_cndmask_b32 v8, v8, v10, s[32:33]
  v_fma_f32 v7, v6, v6, s21
  v_fma_f32 v6, v6, -s20, v4
  v_add_f32_dpp v8, v8, v8 row_ror:4 row_mask:0xf bank_mask:0xf
  v_mul_f32 v6, s28, v6
  v_add_f32_dpp v24, v24, v24 quad_perm:[1,0,3,2] row_mask:0xf bank_mask:0xf
  v_add_f32_dpp v8, v8, v8 row_ror:8 row_mask:0xf bank_mask:0xf
  v_fma_f32 v8, v7, s22, v8
  v_max_f32 v8, s23, v8
  v_rsq_f32 v8, v8
  s_nop 0
  v_mul_f32 v6, v6, v8
  v_add_f32_dpp v25, v25, v25 quad_perm:[1,0,3,2] row_mask:0xf bank_mask:0xf
  v_add_f32_dpp v26, v26, v26 quad_perm:[1,0,3,2] row_mask:0xf bank_mask:0xf
  v_max_f32_dpp v7, v6, v6 quad_perm:[1,0,3,2] row_mask:0xf bank_mask:0xf
  v_add_f32_dpp v27, v27, v27 quad_perm:[1,0,3,2] row_mask:0xf bank_mask:0xf
  v_cndmask_b32 v24, v24, v25, s[30:31]
  v_max_f32_dpp v7, v7, v7 quad_perm:[2,3,0,1] row_mask:0xf bank_mask:0xf
  v_mov_b32 v12, v7
  v_cndmask_b32 v26, v26, v27, s[30:31]
  v_add_f32_dpp v24, v24, v24 quad_perm:[2,3,0,1] row_mask:0xf bank_mask:0xf
  v_permlane16_swap_b32 v12, v7
  v_max_f32 v7, v7, v12
  v_sub_f32 v6, v6, v7
  v_exp_f32 v6, v6
  v_add_f32_dpp v26, v26, v26 quad_perm:[2,3,0,1] row_mask:0xf bank_mask:0xf
  s_nop 0
  v_add_f32_dpp v7, v6, v6 quad_perm:[1,0,3,2] row_mask:0xf bank_mask:0xf
  v_cndmask_b32 v24, v24, v26, s[32:33]
  v_mov_b32_dpp v126, v5 row_ror:4 row_mask:0xf bank_mask:0xf
  v_add_f32_dpp v7, v7, v7 quad_perm:[2,3,0,1] row_mask:0xf bank_mask:0xf
  v_mov_b32 v12, v7
  v_add_f32_dpp v24, v24, v24 row_ror:4 row_mask:0xf bank_mask:0xf
  v_fma_f32 v127, v126, v126, s21
  v_permlane16_swap_b32 v12, v7
  v_add_f32 v7, v7, v12
  v_rcp_f32 v7, v7
  s_nop 0
  v_mul_f32 v6, v6, v7
  v_add_f32_dpp v24, v24, v24 row_ror:8 row_mask:0xf bank_mask:0xf
  v_fma_f32 v126, v126, -s20, v5
  v_mov_b32_dpp v8, v6 row_newbcast:12 row_mask:0xf bank_mask:0xf
  v_mov_b32_dpp v9, v6 row_newbcast:13 row_mask:0xf bank_mask:0xf
  v_mov_b32_dpp v10, v6 row_newbcast:14 row_mask:0xf bank_mask:0xf
  v_mov_b32_dpp v11, v6 row_newbcast:15 row_mask:0xf bank_mask:0xf
  v_mul_f32 v126, s28, v126
  v_fma_f32 v24, v127, s22, v24
  v_max_f32 v24, s23, v24
  v_rsq_f32 v24, v24
  s_nop 0
  v_mul_f32 v126, v126, v24
  v_mul_f32 v40, v40, v8
  v_fmac_f32 v40, v41, v9
  v_max_f32_dpp v127, v126, v126 quad_perm:[1,0,3,2] row_mask:0xf bank_mask:0xf
  v_fmac_f32 v40, v42, v10
  v_fmac_f32 v40, v43, v11
  v_max_f32_dpp v127, v127, v127 quad_perm:[2,3,0,1] row_mask:0xf bank_mask:0xf
  v_mov_b32 v28, v127
  v_mul_f32 v48, v48, v8
  v_fmac_f32 v48, v49, v9
  v_permlane16_swap_b32 v28, v127
  v_max_f32 v127, v127, v28
  v_sub_f32 v126, v126, v127
  v_exp_f32 v126, v126
  v_fmac_f32 v48, v50, v10
  s_nop 0
  v_add_f32_dpp v127, v126, v126 quad_perm:[1,0,3,2] row_mask:0xf bank_mask:0xf
  v_fmac_f32 v48, v51, v11
  v_mul_f32 v56, v56, v8
  v_add_f32_dpp v127, v127, v127 quad_perm:[2,3,0,1] row_mask:0xf bank_mask:0xf
  v_mov_b32 v28, v127
  v_fmac_f32 v56, v57, v9
  v_fmac_f32 v56, v58, v10
  v_permlane16_swap_b32 v28, v127
  v_add_f32 v127, v127, v28
  v_rcp_f32 v127, v127
  s_nop 0
  v_mul_f32 v126, v126, v127
  v_fmac_f32 v56, v59, v11
  v_mul_f32 v64, v64, v8
  v_mov_b32_dpp v24, v126 row_newbcast:12 row_mask:0xf bank_mask:0xf
  v_mov_b32_dpp v25, v126 row_newbcast:13 row_mask:0xf bank_mask:0xf
  v_mov_b32_dpp v26, v126 row_newbcast:14 row_mask:0xf bank_mask:0xf
  v_mov_b32_dpp v27, v126 row_newbcast:15 row_mask:0xf bank_mask:0xf
  v_fmac_f32 v64, v65, v9
  v_fmac_f32 v64, v66, v10
  v_fmac_f32 v64, v67, v11
  v_mul_f32 v72, v72, v8
  v_fmac_f32 v72, v73, v9
  v_fmac_f32 v72, v74, v10
  v_fmac_f32 v72, v75, v11
  v_mul_f32 v80, v80, v8
  v_fmac_f32 v80, v81, v9
  v_fmac_f32 v80, v82, v10
  v_fmac_f32 v80, v83, v11
  v_mul_f32 v88, v88, v8
  v_fmac_f32 v88, v89, v9
  v_fmac_f32 v88, v90, v10
  v_fmac_f32 v88, v91, v11
  v_mul_f32 v96, v96, v8
  v_fmac_f32 v96, v97, v9
  v_fmac_f32 v96, v98, v10
  v_fmac_f32 v96, v99, v11
  v_permlane16_swap_b32 v40, v72
  v_add_f32 v40, v40, v72
  v_permlane16_swap_b32 v48, v80
  v_add_f32 v48, v48, v80
  v_permlane16_swap_b32 v56, v88
  v_add_f32 v56, v56, v88
  v_permlane16_swap_b32 v64, v96
  v_add_f32 v64, v64, v96
  v_cvt_pk_bf16_f32 v40, v40, v48
  v_cvt_pk_bf16_f32 v41, v56, v64
  v_mul_f32 v44, v44, v24
  v_fmac_f32 v44, v45, v25
  v_fmac_f32 v44, v46, v26
  v_fmac_f32 v44, v47, v27
  v_mul_f32 v52, v52, v24
  v_fmac_f32 v52, v53, v25
  v_fmac_f32 v52, v54, v26
  v_fmac_f32 v52, v55, v27
  v_mul_f32 v60, v60, v24
  v_fmac_f32 v60, v61, v25
  v_fmac_f32 v60, v62, v26
  v_fmac_f32 v60, v63, v27
  v_mul_f32 v68, v68, v24
  v_fmac_f32 v68, v69, v25
  v_fmac_f32 v68, v70, v26
  v_fmac_f32 v68, v71, v27
  v_mul_f32 v76, v76, v24
  v_fmac_f32 v76, v77, v25
  v_fmac_f32 v76, v78, v26
  v_fmac_f32 v76, v79, v27
  v_mul_f32 v84, v84, v24
  v_fmac_f32 v84, v85, v25
  v_fmac_f32 v84, v86, v26
  v_fmac_f32 v84, v87, v27
  v_mul_f32 v92, v92, v24
  v_fmac_f32 v92, v93, v25
  v_fmac_f32 v92, v94, v26
  v_fmac_f32 v92, v95, v27
  v_mul_f32 v100, v100, v24
  v_fmac_f32 v100, v101, v25
  v_fmac_f32 v100, v102, v26
  v_fmac_f32 v100, v103, v27
  v_permlane16_swap_b32 v44, v76
  v_add_f32 v44, v44, v76
  v_permlane16_swap_b32 v52, v84
  v_add_f32 v52, v52, v84
  v_permlane16_swap_b32 v60, v92
  v_add_f32 v60, v60, v92
  v_permlane16_swap_b32 v68, v100
  v_add_f32 v68, v68, v100
  v_cvt_pk_bf16_f32 v44, v44, v52
  v_cvt_pk_bf16_f32 v45, v60, v68
  v_cndmask_b32_dpp v42, v41, v40, vcc quad_perm:[2,3,0,1] row_mask:0xf bank_mask:0xf
  v_bfe_u32 v104, v0, 4, 2
  v_cndmask_b32_dpp v46, v45, v44, vcc quad_perm:[2,3,0,1] row_mask:0xf bank_mask:0xf
  s_mov_b64 vcc, s[32:33]
  v_cndmask_b32_dpp v43, v40, v41, vcc quad_perm:[2,3,0,1] row_mask:0xf bank_mask:0xf
  v_cndmask_b32_dpp v47, v44, v45, vcc quad_perm:[2,3,0,1] row_mask:0xf bank_mask:0xf
  v_bfe_u32 v105, v0, 6, 2
  v_lshlrev_b32 v104, 3, v104
  v_lshl_or_b32 v104, v105, 6, v104
  v_bfe_u32 v105, v0, 8, 1
  v_lshl_or_b32 v104, v105, 5, v104
  v_bfe_u32 v105, v0, 9, 1
  v_lshl_or_b32 v104, v105, 8, v104
  v_mov_b32_dpp v40, v42 quad_perm:[1,0,3,2] row_mask:0xf bank_mask:0xf
  v_mov_b32_dpp v41, v43 quad_perm:[1,0,3,2] row_mask:0xf bank_mask:0xf
  v_perm_b32 v40, v40, v42, v3
  v_perm_b32 v41, v41, v43, v3
  buffer_store_dwordx2 v[40:41], v104, s[16:19], s29 offen offset:0 sc1
  v_mov_b32_dpp v44, v46 quad_perm:[1,0,3,2] row_mask:0xf bank_mask:0xf
  v_mov_b32_dpp v45, v47 quad_perm:[1,0,3,2] row_mask:0xf bank_mask:0xf
  v_perm_b32 v44, v44, v46, v3
  v_perm_b32 v45, v45, v47, v3
  buffer_store_dwordx2 v[44:45], v104, s[16:19], s29 offen offset:2048 sc1
K4_D:
K4_END:
  s_endpgm
K4_PW:
  ds_read_b32 v120, v0
  s_waitcnt lgkmcnt(0)
  v_readfirstlane_b32 s49, v120
  s_bitcmp0_b32 s49, 10
  s_cbranch_scc0 K4_P1
  s_sleep 1
  s_branch K4_PW
K4_X:
  s_mov_b32 s29, s43
  s_setprio 3
  v_mfma_f32_16x16x32_bf16 v[88:91], v[10:13], v[10:13], 0
  ds_read_b128 v[108:111], v0 offset:1024
  ds_read_b128 v[112:115], v0 offset:2048
  v_mfma_f32_16x16x32_bf16 v[92:95], v[10:13], v[72:75], 0
  ds_read_b128 v[116:119], v0 offset:3072
  ds_read_b128 v[56:59], v0 offset:4096
  v_mfma_f32_16x16x32_bf16 v[88:91], v[16:19], v[16:19], v[88:91]
  ds_read_b128 v[60:63], v0 offset:5120
  ds_read_b128 v[64:67], v0 offset:6144
  v_mfma_f32_16x16x32_bf16 v[92:95], v[16:19], v[76:79], v[92:95]
  ds_read_b128 v[68:71], v0 offset:7168
  s_mov_b64 vcc, s[38:39]
  v_mfma_f32_16x16x32_bf16 v[88:91], v[22:25], v[22:25], v[88:91]
  v_mfma_f32_16x16x32_bf16 v[92:95], v[22:25], v[80:83], v[92:95]
  v_mfma_f32_16x16x32_bf16 v[88:91], v[28:31], v[28:31], v[88:91]
  v_mfma_f32_16x16x32_bf16 v[92:95], v[28:31], v[84:87], v[92:95]
  v_mfma_f32_16x16x32_bf16 v[72:75], v[104:107], v[10:13], 0
  ds_read_b128 v[104:107], v0 offset:8192
  s_nop 4
  v_cndmask_b32 v88, v88, v89, s[30:31]
  s_waitcnt lgkmcnt(7)
  v_mfma_f32_16x16x32_bf16 v[72:75], v[108:111], v[16:19], v[72:75]
  ds_read_b128 v[108:111], v0 offset:9216
  v_cndmask_b32 v90, v90, v91, s[30:31]
  s_waitcnt lgkmcnt(7)
  v_mfma_f32_16x16x32_bf16 v[72:75], v[112:115], v[22:25], v[72:75]
  ds_read_b128 v[112:115], v0 offset:10240
  v_cndmask_b32 v6, v88, v90, s[32:33]
  s_waitcnt lgkmcnt(7)
  v_mfma_f32_16x16x32_bf16 v[72:75], v[116:119], v[28:31], v[72:75]
  ds_read_b128 v[116:119], v0 offset:11264
  v_cndmask_b32 v88, v92, v93, s[30:31]
  s_waitcnt lgkmcnt(7)
  v_mfma_f32_16x16x32_bf16 v[80:83], v[56:59], v[10:13], 0
  ds_read_b128 v[56:59], v0 offset:12288
  v_cndmask_b32 v89, v94, v95, s[30:31]
  s_waitcnt lgkmcnt(7)
  v_mfma_f32_16x16x32_bf16 v[80:83], v[60:63], v[16:19], v[80:83]
  ds_read_b128 v[60:63], v0 offset:13312
  v_cndmask_b32 v4, v88, v89, s[32:33]
  s_waitcnt lgkmcnt(7)
  v_mfma_f32_16x16x32_bf16 v[80:83], v[64:67], v[22:25], v[80:83]
  ds_read_b128 v[64:67], v0 offset:14336
  v_cvt_pk_bf16_f32 v92, v92, v93
  s_waitcnt lgkmcnt(7)
  v_mfma_f32_16x16x32_bf16 v[80:83], v[68:71], v[28:31], v[80:83]
  ds_read_b128 v[68:71], v0 offset:15360
  v_cvt_pk_bf16_f32 v93, v94, v95
  v_mov_b32_dpp v6, v6 row_shr:4 row_mask:0x5 bank_mask:0xa
  v_fma_f32 v7, v4, v4, s21
  v_cvt_pk_bf16_f32 v40, v72, v73
  v_mov_b32_dpp v6, v6 row_shl:4 row_mask:0xa bank_mask:0x5
  v_mov_b32_dpp v7, v7 row_shr:4 row_mask:0xf bank_mask:0x2
  v_cvt_pk_bf16_f32 v41, v74, v75
  s_waitcnt lgkmcnt(7)
  v_mfma_f32_16x16x32_bf16 v[72:75], v[104:107], v[10:13], 0
  ds_read_b128 v[104:107], v0 offset:16384
  v_mov_b32_dpp v7, v7 row_shr:8 row_mask:0xf bank_mask:0xc
  s_waitcnt lgkmcnt(7)
  v_mfma_f32_16x16x32_bf16 v[72:75], v[108:111], v[16:19], v[72:75]
  ds_read_b128 v[108:111], v0 offset:17408
  v_fma_f32 v6, v7, s22, v6
  s_waitcnt lgkmcnt(7)
  v_mfma_f32_16x16x32_bf16 v[72:75], v[112:115], v[22:25], v[72:75]
  ds_read_b128 v[112:115], v0 offset:18432
  v_max_f32 v6, s23, v6
  s_waitcnt lgkmcnt(7)
  v_mfma_f32_16x16x32_bf16 v[72:75], v[116:119], v[28:31], v[72:75]
  ds_read_b128 v[116:119], v0 offset:19456
  v_rsq_f32 v94, v6
  s_nop 0
  v_mov_b32 v6, v94
  v_mov_b32 v7, v94
  v_cvt_pk_bf16_f32 v42, v80, v81
  v_cvt_pk_bf16_f32 v43, v82, v83
  s_waitcnt lgkmcnt(7)
  v_mfma_f32_16x16x32_bf16 v[80:83], v[56:59], v[10:13], 0
  ds_read_b128 v[56:59], v0 offset:20480
  v_permlane16_swap_b32 v6, v7
  v_mfma_f32_16x16x32_bf16 v[88:91], v[10:13], v[40:43], 0
  v_cndmask_b32 v95, v6, v7, s[34:35]
  v_cvt_pk_bf16_f32 v44, v72, v73
  s_waitcnt lgkmcnt(7)
  v_mfma_f32_16x16x32_bf16 v[80:83], v[60:63], v[16:19], v[80:83]
  ds_read_b128 v[60:63], v0 offset:21504
  v_cvt_pk_bf16_f32 v45, v74, v75
  s_waitcnt lgkmcnt(7)
  v_mfma_f32_16x16x32_bf16 v[80:83], v[64:67], v[22:25], v[80:83]
  ds_read_b128 v[64:67], v0 offset:22528
  s_waitcnt lgkmcnt(7)
  v_mfma_f32_16x16x32_bf16 v[80:83], v[68:71], v[28:31], v[80:83]
  ds_read_b128 v[68:71], v0 offset:23552
  s_waitcnt lgkmcnt(7)
  v_mfma_f32_16x16x32_bf16 v[72:75], v[104:107], v[10:13], 0
  ds_read_b128 v[104:107], v0 offset:24576
  s_waitcnt lgkmcnt(7)
  v_mfma_f32_16x16x32_bf16 v[72:75], v[108:111], v[16:19], v[72:75]
  ds_read_b128 v[108:111], v0 offset:25600
  s_nop 0
  v_cvt_pk_bf16_f32 v46, v80, v81
  s_waitcnt lgkmcnt(7)
  v_mfma_f32_16x16x32_bf16 v[72:75], v[112:115], v[22:25], v[72:75]
  ds_read_b128 v[112:115], v0 offset:26624
  v_cvt_pk_bf16_f32 v47, v82, v83
  s_waitcnt lgkmcnt(7)
  v_mfma_f32_16x16x32_bf16 v[72:75], v[116:119], v[28:31], v[72:75]
  ds_read_b128 v[116:119], v0 offset:27648
  v_mfma_f32_16x16x32_bf16 v[88:91], v[16:19], v[44:47], v[88:91]
  s_waitcnt lgkmcnt(7)
  v_mfma_f32_16x16x32_bf16 v[80:83], v[56:59], v[10:13], 0
  ds_read_b128 v[56:59], v0 offset:28672
  s_nop 2
  v_cvt_pk_bf16_f32 v48, v72, v73
  s_waitcnt lgkmcnt(7)
  v_mfma_f32_16x16x32_bf16 v[80:83], v[60:63], v[16:19], v[80:83]
  ds_read_b128 v[60:63], v0 offset:29696
  v_cvt_pk_bf16_f32 v49, v74, v75
  s_waitcnt lgkmcnt(7)
  v_mfma_f32_16x16x32_bf16 v[80:83], v[64:67], v[22:25], v[80:83]
  ds_read_b128 v[64:67], v0 offset:30720
  s_waitcnt lgkmcnt(7)
  v_mfma_f32_16x16x32_bf16 v[80:83], v[68:71], v[28:31], v[80:83]
  ds_read_b128 v[68:71], v0 offset:31744
  s_waitcnt lgkmcnt(7)
  v_mfma_f32_16x16x32_bf16 v[72:75], v[104:107], v[10:13], 0
  ds_read_b128 v[104:107], v0 offset:32768
  s_waitcnt lgkmcnt(7)
  v_mfma_f32_16x16x32_bf16 v[72:75], v[108:111], v[16:19], v[72:75]
  ds_read_b128 v[108:111], v0 offset:33792
  s_nop 0
  v_cvt_pk_bf16_f32 v50, v80, v81
  s_waitcnt lgkmcnt(7)
  v_mfma_f32_16x16x32_bf16 v[72:75], v[112:115], v[22:25], v[72:75]
  ds_read_b128 v[112:115], v0 offset:34816
  v_cvt_pk_bf16_f32 v51, v82, v83
  s_waitcnt lgkmcnt(7)
  v_mfma_f32_16x16x32_bf16 v[72:75], v[116:119], v[28:31], v[72:75]
  ds_read_b128 v[116:119], v0 offset:35840
  v_mfma_f32_16x16x32_bf16 v[88:91], v[22:25], v[48:51], v[88:91]
  s_waitcnt lgkmcnt(7)
  v_mfma_f32_16x16x32_bf16 v[80:83], v[56:59], v[10:13], 0
  ds_read_b128 v[56:59], v0 offset:36864
  s_nop 2
  v_cvt_pk_bf16_f32 v52, v72, v73
  s_waitcnt lgkmcnt(7)
  v_mfma_f32_16x16x32_bf16 v[80:83], v[60:63], v[16:19], v[80:83]
  ds_read_b128 v[60:63], v0 offset:37888
  v_cvt_pk_bf16_f32 v53, v74, v75
  s_waitcnt lgkmcnt(7)
  v_mfma_f32_16x16x32_bf16 v[80:83], v[64:67], v[22:25], v[80:83]
  ds_read_b128 v[64:67], v0 offset:38912
  s_waitcnt lgkmcnt(7)
  v_mfma_f32_16x16x32_bf16 v[80:83], v[68:71], v[28:31], v[80:83]
  ds_read_b128 v[68:71], v0 offset:39936
  s_waitcnt lgkmcnt(7)
  v_mfma_f32_16x16x32_bf16 v[40:43], v[10:13], v[104:107], 0
  ds_read_b128 v[104:107], v0 offset:40960
  s_waitcnt lgkmcnt(7)
  v_mfma_f32_16x16x32_bf16 v[40:43], v[16:19], v[108:111], v[40:43]
  ds_read_b128 v[108:111], v0 offset:41984
  s_nop 0
  v_cvt_pk_bf16_f32 v54, v80, v81
  s_waitcnt lgkmcnt(7)
  v_mfma_f32_16x16x32_bf16 v[40:43], v[22:25], v[112:115], v[40:43]
  ds_read_b128 v[112:115], v0 offset:43008
  v_cvt_pk_bf16_f32 v55, v82, v83
  s_waitcnt lgkmcnt(7)
  v_mfma_f32_16x16x32_bf16 v[40:43], v[28:31], v[116:119], v[40:43]
  ds_read_b128 v[116:119], v0 offset:44032
  v_mfma_f32_16x16x32_bf16 v[88:91], v[28:31], v[52:55], v[88:91]
  s_waitcnt lgkmcnt(7)
  v_mfma_f32_16x16x32_bf16 v[44:47], v[10:13], v[56:59], 0
  ds_read_b128 v[56:59], v0 offset:45056
  s_nop 2
  v_cvt_pk_bf16_f32 v40, v40, v41
  s_waitcnt lgkmcnt(7)
  v_mfma_f32_16x16x32_bf16 v[44:47], v[16:19], v[60:63], v[44:47]
  ds_read_b128 v[60:63], v0 offset:46080
  v_mul_f32_dpp v88, v94, v88 quad_perm:[0,0,0,0] row_mask:0xf bank_mask:0xf
  s_waitcnt lgkmcnt(7)
  v_mfma_f32_16x16x32_bf16 v[44:47], v[22:25], v[64:67], v[44:47]
  ds_read_b128 v[64:67], v0 offset:47104
  v_mul_f32_dpp v89, v94, v89 quad_perm:[1,1,1,1] row_mask:0xf bank_mask:0xf
  s_waitcnt lgkmcnt(7)
  v_mfma_f32_16x16x32_bf16 v[44:47], v[28:31], v[68:71], v[44:47]
  ds_read_b128 v[68:71], v0 offset:48128
  v_mul_f32_dpp v90, v94, v90 quad_perm:[2,2,2,2] row_mask:0xf bank_mask:0xf
  s_waitcnt lgkmcnt(7)
  v_mfma_f32_16x16x32_bf16 v[48:51], v[10:13], v[104:107], 0
  ds_read_b128 v[104:107], v0 offset:49152
  v_mul_f32_dpp v91, v94, v91 quad_perm:[3,3,3,3] row_mask:0xf bank_mask:0xf
  s_waitcnt lgkmcnt(7)
  v_mfma_f32_16x16x32_bf16 v[48:51], v[16:19], v[108:111], v[48:51]
  ds_read_b128 v[108:111], v0 offset:50176
  v_max3_f32 v6, v88, v89, v90
  s_waitcnt lgkmcnt(7)
  v_mfma_f32_16x16x32_bf16 v[48:51], v[22:25], v[112:115], v[48:51]
  ds_read_b128 v[112:115], v0 offset:51200
  v_max_f32 v6, v6, v91
  s_waitcnt lgkmcnt(7)
  v_mfma_f32_16x16x32_bf16 v[48:51], v[28:31], v[116:119], v[48:51]
  ds_read_b128 v[116:119], v0 offset:52224
  v_mov_b32 v7, v6
  s_waitcnt lgkmcnt(7)
  v_mfma_f32_16x16x32_bf16 v[52:55], v[10:13], v[56:59], 0
  ds_read_b128 v[56:59], v0 offset:53248
  v_permlane16_swap_b32 v7, v6
  s_waitcnt lgkmcnt(7)
  v_mfma_f32_16x16x32_bf16 v[52:55], v[16:19], v[60:63], v[52:55]
  ds_read_b128 v[60:63], v0 offset:54272
  v_max_f32 v6, v6, v7
  s_waitcnt lgkmcnt(7)
  v_mfma_f32_16x16x32_bf16 v[52:55], v[22:25], v[64:67], v[52:55]
  ds_read_b128 v[64:67], v0 offset:55296
  v_mul_f32 v6, -v95, v6
  s_waitcnt lgkmcnt(7)
  v_mfma_f32_16x16x32_bf16 v[52:55], v[28:31], v[68:71], v[52:55]
  ds_read_b128 v[68:71], v0 offset:56320
  v_fma_f32 v88, v88, v95, v6
  s_waitcnt lgkmcnt(7)
  v_mfma_f32_16x16x32_bf16 v[72:75], v[10:13], v[104:107], 0
  ds_read_b128 v[104:107], v0 offset:57344
  v_fma_f32 v89, v89, v95, v6
  s_waitcnt lgkmcnt(7)
  v_mfma_f32_16x16x32_bf16 v[72:75], v[16:19], v[108:111], v[72:75]
  ds_read_b128 v[108:111], v0 offset:58368
  v_fma_f32 v90, v90, v95, v6
  s_waitcnt lgkmcnt(7)
  v_mfma_f32_16x16x32_bf16 v[72:75], v[22:25], v[112:115], v[72:75]
  ds_read_b128 v[112:115], v0 offset:59392
  v_fma_f32 v91, v91, v95, v6
  s_waitcnt lgkmcnt(7)
  v_mfma_f32_16x16x32_bf16 v[72:75], v[28:31], v[116:119], v[72:75]
  ds_read_b128 v[116:119], v0 offset:60416
  v_exp_f32 v88, v88
  s_waitcnt lgkmcnt(7)
  v_mfma_f32_16x16x32_bf16 v[76:79], v[10:13], v[56:59], 0
  ds_read_b128 v[56:59], v0 offset:61440
  v_exp_f32 v89, v89
  s_waitcnt lgkmcnt(7)
  v_mfma_f32_16x16x32_bf16 v[76:79], v[16:19], v[60:63], v[76:79]
  ds_read_b128 v[60:63], v0 offset:62464
  v_exp_f32 v90, v90
  s_waitcnt lgkmcnt(7)
  v_mfma_f32_16x16x32_bf16 v[76:79], v[22:25], v[64:67], v[76:79]
  ds_read_b128 v[64:67], v0 offset:63488
  v_exp_f32 v91, v91
  s_waitcnt lgkmcnt(7)
  v_mfma_f32_16x16x32_bf16 v[76:79], v[28:31], v[68:71], v[76:79]
  ds_read_b128 v[68:71], v0 offset:64512
  v_add_f32 v6, v88, v89
  s_waitcnt lgkmcnt(7)
  v_mfma_f32_16x16x32_bf16 v[80:83], v[10:13], v[104:107], 0
  v_add_f32 v7, v90, v91
  v_add_f32 v6, v6, v7
  s_waitcnt lgkmcnt(6)
  v_mfma_f32_16x16x32_bf16 v[80:83], v[16:19], v[108:111], v[80:83]
  v_mov_b32 v7, v6
  v_mul_f32_dpp v88, v94, v88 quad_perm:[0,0,0,0] row_mask:0xf bank_mask:0xf
  s_waitcnt lgkmcnt(5)
  v_mfma_f32_16x16x32_bf16 v[80:83], v[22:25], v[112:115], v[80:83]
  v_permlane16_swap_b32 v7, v6
  v_add_f32 v6, v6, v7
  s_waitcnt lgkmcnt(4)
  v_mfma_f32_16x16x32_bf16 v[80:83], v[28:31], v[116:119], v[80:83]
  v_rcp_f32 v6, v6
  s_waitcnt lgkmcnt(3)
  v_mfma_f32_16x16x32_bf16 v[84:87], v[10:13], v[56:59], 0
  v_mul_f32_dpp v89, v94, v89 quad_perm:[1,1,1,1] row_mask:0xf bank_mask:0xf
  v_mul_f32_dpp v90, v94, v90 quad_perm:[2,2,2,2] row_mask:0xf bank_mask:0xf
  s_waitcnt lgkmcnt(2)
  v_mfma_f32_16x16x32_bf16 v[84:87], v[16:19], v[60:63], v[84:87]
  v_mul_f32_dpp v91, v94, v91 quad_perm:[3,3,3,3] row_mask:0xf bank_mask:0xf
  v_mul_f32 v88, v88, v6
  s_waitcnt lgkmcnt(1)
  v_mfma_f32_16x16x32_bf16 v[84:87], v[22:25], v[64:67], v[84:87]
  v_mul_f32 v89, v89, v6
  v_mul_f32 v90, v90, v6
  s_waitcnt lgkmcnt(0)
  v_mfma_f32_16x16x32_bf16 v[84:87], v[28:31], v[68:71], v[84:87]
  v_mul_f32 v91, v91, v6
  v_cvt_pk_bf16_f32 v88, v88, v89
  v_cvt_pk_bf16_f32 v89, v90, v91
  v_cndmask_b32 v8, 0, v88, s[36:37]
  v_cndmask_b32 v9, 0, v89, s[36:37]
  v_cndmask_b32 v14, 0, v88, s[36:37]
  v_cndmask_b32 v15, 0, v89, s[36:37]
  v_cndmask_b32 v20, 0, v88, s[36:37]
  v_cndmask_b32 v21, 0, v89, s[36:37]
  v_cndmask_b32 v26, 0, v88, s[36:37]
  v_cndmask_b32 v27, 0, v89, s[36:37]
  v_cndmask_b32 v32, 0, v88, s[36:37]
  v_cndmask_b32 v33, 0, v89, s[36:37]
  v_mfma_f32_16x16x16_bf16 v[88:91], v[8:9], v[92:93], 0
  v_cvt_pk_bf16_f32 v41, v42, v43
  v_mov_b32 v42, v122
  v_mov_b32 v43, v123
  v_cvt_pk_bf16_f32 v47, v46, v47
  v_cvt_pk_bf16_f32 v46, v44, v45
  v_mfma_f32_16x16x32_bf16 v[40:43], v[8:11], v[40:43], 0
  s_nop 1
  v_cndmask_b32 v88, v88, v89, s[30:31]
  v_cndmask_b32 v90, v90, v91, s[30:31]
  v_cndmask_b32 v6, v88, v90, s[32:33]
  v_mov_b32 v44, v122
  v_mov_b32 v45, v123
  v_add_f32_dpp v4, v4, v6 row_ror:8 row_mask:0xf bank_mask:0xf
  v_cvt_pk_bf16_f32 v48, v48, v49
  v_mfma_f32_16x16x32_bf16 v[44:47], v[12:15], v[44:47], 0
  v_cvt_pk_bf16_f32 v49, v50, v51
  v_mov_b32 v50, v122
  v_mov_b32 v51, v123
  v_cvt_pk_bf16_f32 v55, v54, v55
  v_cvt_pk_bf16_f32 v54, v52, v53
  v_mfma_f32_16x16x32_bf16 v[48:51], v[14:17], v[48:51], 0
  v_mov_b32 v52, v122
  v_mov_b32 v53, v123
  v_cvt_pk_bf16_f32 v72, v72, v73
  v_cvt_pk_bf16_f32 v73, v74, v75
  v_mfma_f32_16x16x32_bf16 v[52:55], v[18:21], v[52:55], 0
  v_mov_b32 v74, v122
  v_mov_b32 v75, v123
  v_cvt_pk_bf16_f32 v79, v78, v79
  v_cvt_pk_bf16_f32 v78, v76, v77
  v_mfma_f32_16x16x32_bf16 v[72:75], v[20:23], v[72:75], 0
  v_mov_b32 v76, v122
  v_mov_b32 v77, v123
  v_cvt_pk_bf16_f32 v80, v80, v81
  v_cvt_pk_bf16_f32 v81, v82, v83
  v_mfma_f32_16x16x32_bf16 v[76:79], v[24:27], v[76:79], 0
  v_mov_b32 v82, v122
  v_mov_b32 v83, v123
  v_cvt_pk_bf16_f32 v87, v86, v87
  v_cvt_pk_bf16_f32 v86, v84, v85
  v_mfma_f32_16x16x32_bf16 v[80:83], v[26:29], v[80:83], 0
  v_mov_b32 v84, v122
  v_mov_b32 v85, v123
  s_setprio 0
  v_mul_f32 v96, v40, v40
  v_mfma_f32_16x16x32_bf16 v[84:87], v[30:33], v[84:87], 0
  v_mul_f32 v97, v41, v41
  v_mul_f32 v98, v42, v42
  v_mul_f32 v99, v43, v43
  v_fmac_f32 v96, v44, v44
  v_fmac_f32 v97, v45, v45
  v_fmac_f32 v98, v46, v46
  v_fmac_f32 v99, v47, v47
  v_fmac_f32 v96, v48, v48
  v_fmac_f32 v97, v49, v49
  v_fmac_f32 v98, v50, v50
  v_fmac_f32 v99, v51, v51
  v_fmac_f32 v96, v52, v52
  v_fmac_f32 v97, v53, v53
  v_fmac_f32 v98, v54, v54
  v_fmac_f32 v99, v55, v55
  v_fmac_f32 v96, v72, v72
  v_fmac_f32 v97, v73, v73
  v_fmac_f32 v98, v74, v74
  v_fmac_f32 v99, v75, v75
  v_fmac_f32 v96, v76, v76
  v_fmac_f32 v97, v77, v77
  v_fmac_f32 v98, v78, v78
  v_fmac_f32 v99, v79, v79
  v_fmac_f32 v96, v80, v80
  v_fmac_f32 v97, v81, v81
  v_fmac_f32 v98, v82, v82
  v_fmac_f32 v99, v83, v83
  v_fmac_f32 v96, v84, v84
  v_fmac_f32 v97, v85, v85
  v_fmac_f32 v98, v86, v86
  v_fmac_f32 v99, v87, v87
  v_add_f32_dpp v96, v96, v96 quad_perm:[1,0,3,2] row_mask:0xf bank_mask:0xf
  v_add_f32_dpp v97, v97, v97 quad_perm:[1,0,3,2] row_mask:0xf bank_mask:0xf
  v_add_f32_dpp v98, v98, v98 quad_perm:[1,0,3,2] row_mask:0xf bank_mask:0xf
  v_add_f32_dpp v99, v99, v99 quad_perm:[1,0,3,2] row_mask:0xf bank_mask:0xf
  v_cndmask_b32 v96, v96, v97, s[30:31]
  v_cndmask_b32 v98, v98, v99, s[30:31]
  v_mov_b32_dpp v6, v4 row_ror:4 row_mask:0xf bank_mask:0xf
  v_add_f32_dpp v96, v96, v96 quad_perm:[2,3,0,1] row_mask:0xf bank_mask:0xf
  v_add_f32_dpp v98, v98, v98 quad_perm:[2,3,0,1] row_mask:0xf bank_mask:0xf
  v_cndmask_b32 v96, v96, v98, s[32:33]
  v_fma_f32 v7, v6, v6, s21
  v_fma_f32 v6, v6, -s20, v4
  v_add_f32_dpp v96, v96, v96 row_ror:4 row_mask:0xf bank_mask:0xf
  v_mul_f32 v6, s28, v6
  v_bfe_u32 v104, v0, 4, 2
  v_add_f32_dpp v96, v96, v96 row_ror:8 row_mask:0xf bank_mask:0xf
  v_fma_f32 v96, v7, s22, v96
  v_max_f32 v96, s23, v96
  v_rsq_f32 v96, v96
  s_nop 0
  v_mul_f32 v6, v6, v96
  v_bfe_u32 v105, v0, 6, 2
  v_lshlrev_b32 v104, 3, v104
  v_max_f32_dpp v7, v6, v6 quad_perm:[1,0,3,2] row_mask:0xf bank_mask:0xf
  v_lshl_or_b32 v104, v105, 6, v104
  v_bfe_u32 v105, v0, 8, 1
  v_max_f32_dpp v7, v7, v7 quad_perm:[2,3,0,1] row_mask:0xf bank_mask:0xf
  v_mov_b32 v100, v7
  v_lshl_or_b32 v104, v105, 5, v104
  v_bfe_u32 v105, v0, 9, 1
  v_permlane16_swap_b32 v100, v7
  v_max_f32 v7, v7, v100
  v_sub_f32 v6, v6, v7
  v_exp_f32 v6, v6
  v_lshl_or_b32 v104, v105, 8, v104
  s_nop 0
  v_add_f32_dpp v7, v6, v6 quad_perm:[1,0,3,2] row_mask:0xf bank_mask:0xf
  s_nop 1
  v_add_f32_dpp v7, v7, v7 quad_perm:[2,3,0,1] row_mask:0xf bank_mask:0xf
  v_mov_b32 v100, v7
  s_nop 1
  v_permlane16_swap_b32 v100, v7
  v_add_f32 v7, v7, v100
  v_rcp_f32 v7, v7
  s_nop 0
  v_mul_f32 v6, v6, v7
  s_nop 1
  v_mov_b32_dpp v96, v6 row_newbcast:12 row_mask:0xf bank_mask:0xf
  v_mov_b32_dpp v97, v6 row_newbcast:13 row_mask:0xf bank_mask:0xf
  v_mov_b32_dpp v98, v6 row_newbcast:14 row_mask:0xf bank_mask:0xf
  v_mov_b32_dpp v99, v6 row_newbcast:15 row_mask:0xf bank_mask:0xf
  v_mul_f32 v40, v40, v96
  v_fmac_f32 v40, v41, v97
  v_fmac_f32 v40, v42, v98
  v_fmac_f32 v40, v43, v99
  v_mul_f32 v44, v44, v96
  v_fmac_f32 v44, v45, v97
  v_fmac_f32 v44, v46, v98
  v_fmac_f32 v44, v47, v99
  v_mul_f32 v48, v48, v96
  v_fmac_f32 v48, v49, v97
  v_fmac_f32 v48, v50, v98
  v_fmac_f32 v48, v51, v99
  v_mul_f32 v52, v52, v96
  v_fmac_f32 v52, v53, v97
  v_fmac_f32 v52, v54, v98
  v_fmac_f32 v52, v55, v99
  v_mul_f32 v72, v72, v96
  v_fmac_f32 v72, v73, v97
  v_fmac_f32 v72, v74, v98
  v_fmac_f32 v72, v75, v99
  v_mul_f32 v76, v76, v96
  v_fmac_f32 v76, v77, v97
  v_fmac_f32 v76, v78, v98
  v_fmac_f32 v76, v79, v99
  v_mul_f32 v80, v80, v96
  v_fmac_f32 v80, v81, v97
  v_fmac_f32 v80, v82, v98
  v_fmac_f32 v80, v83, v99
  v_mul_f32 v84, v84, v96
  v_fmac_f32 v84, v85, v97
  v_fmac_f32 v84, v86, v98
  v_fmac_f32 v84, v87, v99
  v_permlane16_swap_b32 v40, v72
  v_add_f32 v40, v40, v72
  v_permlane16_swap_b32 v44, v76
  v_add_f32 v44, v44, v76
  v_permlane16_swap_b32 v48, v80
  v_add_f32 v48, v48, v80
  v_permlane16_swap_b32 v52, v84
  v_add_f32 v52, v52, v84
  v_cvt_pk_bf16_f32 v40, v40, v44
  v_cvt_pk_bf16_f32 v41, v48, v52
  s_nop 1
  v_cndmask_b32_dpp v42, v41, v40, vcc quad_perm:[2,3,0,1] row_mask:0xf bank_mask:0xf
  s_mov_b64 vcc, s[32:33]
  v_cndmask_b32_dpp v43, v40, v41, vcc quad_perm:[2,3,0,1] row_mask:0xf bank_mask:0xf
  v_mov_b32_dpp v40, v42 quad_perm:[1,0,3,2] row_mask:0xf bank_mask:0xf
  v_perm_b32 v40, v40, v42, v3
  v_mov_b32_dpp v41, v43 quad_perm:[1,0,3,2] row_mask:0xf bank_mask:0xf
  v_perm_b32 v41, v41, v43, v3
  buffer_store_dwordx2 v[40:41], v104, s[16:19], s29 offen offset:0 sc1
  s_endpgm
CODE_END:
  s_endpgm
.section .rodata,"a"
.p2align 6
.amdhsa_kernel k1_kernel
  .amdhsa_next_free_vgpr 64
  .amdhsa_next_free_sgpr 64
  .amdhsa_accum_offset 64
  .amdhsa_group_segment_fixed_size 0
  .amdhsa_kernarg_size 96
  .amdhsa_user_sgpr_count 2
  .amdhsa_user_sgpr_kernarg_segment_ptr 1
  .amdhsa_system_sgpr_workgroup_id_x 1
.end_amdhsa_kernel
.p2align 6
.amdhsa_kernel k2_kernel
  .amdhsa_next_free_vgpr 112
  .amdhsa_next_free_sgpr 64
  .amdhsa_accum_offset 112
  .amdhsa_group_segment_fixed_size 0
  .amdhsa_kernarg_size 96
  .amdhsa_user_sgpr_count 2
  .amdhsa_user_sgpr_kernarg_segment_ptr 1
  .amdhsa_system_sgpr_workgroup_id_x 1
.end_amdhsa_kernel
.p2align 6
.amdhsa_kernel k3_kernel
  .amdhsa_next_free_vgpr 128
  .amdhsa_next_free_sgpr 64
  .amdhsa_accum_offset 128
  .amdhsa_group_segment_fixed_size 0
  .amdhsa_kernarg_size 96
  .amdhsa_user_sgpr_count 2
  .amdhsa_user_sgpr_kernarg_segment_ptr 1
  .amdhsa_system_sgpr_workgroup_id_x 1
.end_amdhsa_kernel
.p2align 6
.amdhsa_kernel k4_kernel
  .amdhsa_next_free_vgpr 128
  .amdhsa_next_free_sgpr 64
  .amdhsa_accum_offset 128
  .amdhsa_group_segment_fixed_size 0
  .amdhsa_kernarg_size 96
  .amdhsa_user_sgpr_count 2
  .amdhsa_user_sgpr_kernarg_segment_ptr 1
  .amdhsa_system_sgpr_workgroup_id_x 1
.end_amdhsa_kernel
```
